```python
import torch

def _softmax(x, axis=-1):
    return torch.softmax(x, dim=axis)
def _gelu(x):
    return torch.nn.functional.gelu(x, approximate="tanh")
def _silu(x):
    return torch.nn.functional.silu(x)
def _sigmoid(x):
    return torch.sigmoid(x)
def _layernorm(x, axis=-1, eps=1e-5):
    m = x.mean(dim=axis, keepdim=True)
    v = x.var(dim=axis, keepdim=True, unbiased=False)
    return (x - m) / torch.sqrt(v + eps)
def _scatter_add(tgt, idx, src, axis=0):
    return tgt.clone().index_add_(axis, idx, src)
def _segment_sum(src, seg, n):
    out = torch.zeros((n,) + src.shape[1:], dtype=src.dtype)
    return out.index_add_(0, seg, src)
def _pad(x, pw):
    flat = tuple(v for pair in reversed(pw) for v in pair)
    return torch.nn.functional.pad(x, flat)

kernel_name = 'recurrent_scan__gqa_block_cached__glu_gated_swiglu__decode'

def setup_inputs():

    _w = (lambda a: (lambda t: t.to(torch.bfloat16) if t.is_floating_point() else t)(torch.as_tensor(a)))
    def _A_setup():
        B, Sq, D = 2, 1, 512
        Hq, Hkv, Sk, Dh = 32, 8, 32768, 128
        assert Hq % Hkv == 0, (Hq, Hkv)
        return {
            "x": _w((lambda *s: torch.randn(*s, dtype=torch.bfloat16) * 0.4)(B, Sq, D)),
            "k_cache": _w((lambda *s: torch.randn(*s, dtype=torch.bfloat16) * 1.6)(B, Hkv, Sk, Dh)),
            "v_cache": _w((lambda *s: torch.randn(*s, dtype=torch.bfloat16) * 1.6)(B, Hkv, Sk, Dh)),
            "wq": _w((lambda *s: torch.randn(*s, dtype=torch.bfloat16) * 1.6)(D, Hq * Dh) * (D ** -0.5)),
            "wo": _w((lambda *s: torch.randn(*s, dtype=torch.bfloat16) * 1.6)(Hq * Dh, D) * ((Hq * Dh) ** -0.5)),
        }
    _A_in = _A_setup()

    def _B_setup():
        B, S, D, F = 2, 1, 512, 1792
        return {
            "x": _w((lambda *s: torch.randn(*s, dtype=torch.bfloat16) * 0.4)(B, S, D)),
            "w1": _w((lambda *s: torch.randn(*s, dtype=torch.bfloat16) * 1.6)(D, F) * (2.0 / D) ** 0.5),
            "w3": _w((lambda *s: torch.randn(*s, dtype=torch.bfloat16) * 1.6)(D, F) * (2.0 / D) ** 0.5),
            "w2": _w((lambda *s: torch.randn(*s, dtype=torch.bfloat16) * 1.6)(F, D) * (2.0 / F) ** 0.5),
        }
    _B_in = _B_setup()

    return {
        "A_x": _A_in["x"],
        "A_k_cache": _A_in["k_cache"],
        "A_v_cache": _A_in["v_cache"],
        "A_wq": _A_in["wq"],
        "A_wo": _A_in["wo"],
        "B_x": _B_in["x"],
        "B_w1": _B_in["w1"],
        "B_w3": _B_in["w3"],
        "B_w2": _B_in["w2"],
    }

def reference(A_x, A_k_cache, A_v_cache, A_wq, A_wo, B_x, B_w1, B_w3, B_w2):
    def _A_ref(x, k_cache, v_cache, wq, wo):
        B, Sq, D = x.shape
        Hq, Dh = 32, 128
        Hkv = k_cache.shape[1]
        rep = Hq // Hkv
        q = (lambda x, *d: x.permute(*d))((x @ wq).reshape(B, Sq, Hq, Dh), 0, 2, 1, 3)
        k = (lambda x, n, axis: torch.repeat_interleave(x, n, dim=axis))(k_cache, rep, axis=1)
        v = (lambda x, n, axis: torch.repeat_interleave(x, n, dim=axis))(v_cache, rep, axis=1)
        scores = torch.einsum("bhqd,bhkd->bhqk", q, k) * (Dh ** -0.5)
        p = _softmax(scores, axis=-1)
        o = torch.einsum("bhqk,bhkd->bhqd", p, v)
        return (lambda x, *d: x.permute(*d))(o, 0, 2, 1, 3).reshape(B, Sq, Hq * Dh) @ wo

    def _B_ref(x, w1, w3, w2):
        gate = torch.einsum("bsd,df->bsf", x, w1)
        up = torch.einsum("bsd,df->bsf", x, w3)
        h = _silu(gate) * up
        out = torch.einsum("bsf,fd->bsd", h, w2)
        return out

    x = A_x
    xn = _layernorm(x, axis=-1)
    s = _A_ref(xn, A_k_cache, A_v_cache, A_wq, A_wo)
    g = _silu(_B_ref(xn, B_w1, B_w3, B_w2))
    return x + s * g
```

```asm
; @launch grid=(256,1,1) block=(512,1,1) lds=147968
.amdgcn_target "amdgcn-amd-amdhsa--gfx950"
.text
.globl recurrent_scan__gqa_block_cached__glu_gated_swiglu__decode_kernel
.p2align 8
.type recurrent_scan__gqa_block_cached__glu_gated_swiglu__decode_kernel,@function
recurrent_scan__gqa_block_cached__glu_gated_swiglu__decode_kernel:
    s_cmp_ge_u32 s2, 256
    s_cbranch_scc1 DONE
    s_load_dwordx16 s[4:19], s[0:1], 0
    s_load_dwordx8 s[20:27], s[0:1], 64
    v_lshrrev_b32 v1, 6, v0
    s_nop 0
    v_readfirstlane_b32 s28, v1
    v_and_b32 v1, 63, v0
    s_lshr_b32 s29, s2, 4
    s_and_b32 s30, s2, 15
    s_lshr_b32 s31, s29, 3
    s_and_b32 s32, s29, 7
    s_lshl_b32 s34, s2, 13
    s_lshr_b32 s35, s2, 5
    v_and_b32 v2, 15, v1
    v_lshrrev_b32 v3, 4, v1
    s_cmp_ge_u32 s28, 4
    s_waitcnt lgkmcnt(0)
    s_mov_b32 s36, s26
    s_mov_b32 s37, s27
    s_mov_b32 s38, 2363392
    s_mov_b32 s39, 0x00020000
    s_mov_b32 s44, s4
    s_mov_b32 s45, s5
    s_mov_b32 s46, 2048
    s_mov_b32 s47, 0x00020000
    s_mov_b32 s60, 0x3fb8aa3b
    s_mov_b32 s61, 0x3db504f3
    s_cbranch_scc1 ROLE_HI
    s_mov_b32 s48, s10
    s_mov_b32 s49, s11
    s_mov_b32 s50, 4194304
    s_mov_b32 s51, 0x00020000
    v_lshlrev_b32 v4, 4, v1
    s_lshl_b32 s33, s31, 10
    buffer_load_dwordx4 v[8:11], v4, s[44:47], s33 offen
    v_lshrrev_b32 v5, 2, v0
    v_and_b32 v6, 3, v0
    v_lshlrev_b32 v7, 16, v5
    v_lshl_add_u32 v7, v6, 4, v7
    s_lshl_b32 s62, s32, 10
    s_lshl_b32 s63, s30, 6
    s_add_u32 s62, s62, s63
    buffer_load_dwordx4 v[32:35], v7, s[48:51], s62 offen nt
    s_add_u32 s62, s62, 8192
    buffer_load_dwordx4 v[36:39], v7, s[48:51], s62 offen nt
    s_add_u32 s62, s62, 8192
    buffer_load_dwordx4 v[40:43], v7, s[48:51], s62 offen nt
    s_add_u32 s62, s62, 8192
    buffer_load_dwordx4 v[44:47], v7, s[48:51], s62 offen nt
    s_add_u32 s62, s62, 8192
    buffer_load_dwordx4 v[48:51], v7, s[48:51], s62 offen nt
    s_add_u32 s62, s62, 8192
    buffer_load_dwordx4 v[52:55], v7, s[48:51], s62 offen nt
    s_add_u32 s62, s62, 8192
    buffer_load_dwordx4 v[56:59], v7, s[48:51], s62 offen nt
    s_add_u32 s62, s62, 8192
    buffer_load_dwordx4 v[60:63], v7, s[48:51], s62 offen nt
    s_barrier
    v_mov_b32 v14, 131072
    v_mov_b32 v15, 1
    s_waitcnt vmcnt(8)
    v_lshlrev_b32 v64, 16, v8
    v_and_b32 v65, 0xffff0000, v8
    v_lshlrev_b32 v66, 16, v9
    v_and_b32 v67, 0xffff0000, v9
    v_lshlrev_b32 v68, 16, v10
    v_and_b32 v69, 0xffff0000, v10
    v_lshlrev_b32 v70, 16, v11
    v_and_b32 v71, 0xffff0000, v11
    v_add_f32 v80, v64, v65
    v_add_f32 v80, v80, v66
    v_add_f32 v80, v80, v67
    v_add_f32 v80, v80, v68
    v_add_f32 v80, v80, v69
    v_add_f32 v80, v80, v70
    v_add_f32 v80, v80, v71
    s_nop 1
    v_add_f32_dpp v80, v80, v80 quad_perm:[1,0,3,2] row_mask:0xf bank_mask:0xf
    s_nop 1
    v_add_f32_dpp v80, v80, v80 quad_perm:[2,3,0,1] row_mask:0xf bank_mask:0xf
    s_nop 1
    v_add_f32_dpp v80, v80, v80 row_ror:4 row_mask:0xf bank_mask:0xf
    s_nop 1
    v_add_f32_dpp v80, v80, v80 row_ror:8 row_mask:0xf bank_mask:0xf
    v_mov_b32 v82, v80
    s_nop 1
    v_permlane16_swap_b32 v80, v82
    s_nop 0
    v_add_f32 v80, v80, v82
    v_mov_b32 v82, v80
    s_nop 1
    v_permlane32_swap_b32 v80, v82
    s_nop 0
    v_add_f32 v80, v80, v82
    v_mul_f32 v80, 0x3b000000, v80
    v_sub_f32 v86, v64, v80
    v_mul_f32 v84, v86, v86
    v_sub_f32 v86, v65, v80
    v_fmac_f32 v84, v86, v86
    v_sub_f32 v86, v66, v80
    v_fmac_f32 v84, v86, v86
    v_sub_f32 v86, v67, v80
    v_fmac_f32 v84, v86, v86
    v_sub_f32 v86, v68, v80
    v_fmac_f32 v84, v86, v86
    v_sub_f32 v86, v69, v80
    v_fmac_f32 v84, v86, v86
    v_sub_f32 v86, v70, v80
    v_fmac_f32 v84, v86, v86
    v_sub_f32 v86, v71, v80
    v_fmac_f32 v84, v86, v86
    s_nop 1
    v_add_f32_dpp v84, v84, v84 quad_perm:[1,0,3,2] row_mask:0xf bank_mask:0xf
    s_nop 1
    v_add_f32_dpp v84, v84, v84 quad_perm:[2,3,0,1] row_mask:0xf bank_mask:0xf
    s_nop 1
    v_add_f32_dpp v84, v84, v84 row_ror:4 row_mask:0xf bank_mask:0xf
    s_nop 1
    v_add_f32_dpp v84, v84, v84 row_ror:8 row_mask:0xf bank_mask:0xf
    v_mov_b32 v82, v84
    s_nop 1
    v_permlane16_swap_b32 v84, v82
    s_nop 0
    v_add_f32 v84, v84, v82
    v_mov_b32 v82, v84
    s_nop 1
    v_permlane32_swap_b32 v84, v82
    s_nop 0
    v_add_f32 v84, v84, v82
    v_mul_f32 v84, 0x3b000000, v84
    v_cvt_pk_bf16_f32 v86, v80, v84
    v_lshlrev_b32 v80, 16, v86
    v_and_b32 v84, 0xffff0000, v86
    v_add_f32 v84, 0x3727c5ac, v84
    v_cvt_pk_bf16_f32 v86, v84, v84
    v_lshlrev_b32 v84, 16, v86
    v_sqrt_f32 v84, v84
    s_nop 0
    v_cvt_pk_bf16_f32 v86, v84, v84
    v_lshlrev_b32 v84, 16, v86
    v_rcp_f32 v87, v84
    s_nop 0
    v_sub_f32 v64, v64, v80
    v_sub_f32 v65, v65, v80
    v_cvt_pk_bf16_f32 v86, v64, v65
    v_lshlrev_b32 v64, 16, v86
    v_and_b32 v65, 0xffff0000, v86
    v_mul_f32 v89, v64, v87
    v_mul_f32 v90, v65, v87
    v_fma_f32 v91, -v89, v84, v64
    v_fma_f32 v92, -v90, v84, v65
    v_fmac_f32 v89, v91, v87
    v_fmac_f32 v90, v92, v87
    v_cvt_pk_bf16_f32 v86, v89, v90
    v_and_b32 v64, 0xffff, v86
    v_lshrrev_b32 v65, 16, v86
    v_sub_f32 v66, v66, v80
    v_sub_f32 v67, v67, v80
    v_cvt_pk_bf16_f32 v86, v66, v67
    v_lshlrev_b32 v66, 16, v86
    v_and_b32 v67, 0xffff0000, v86
    v_mul_f32 v89, v66, v87
    v_mul_f32 v90, v67, v87
    v_fma_f32 v91, -v89, v84, v66
    v_fma_f32 v92, -v90, v84, v67
    v_fmac_f32 v89, v91, v87
    v_fmac_f32 v90, v92, v87
    v_cvt_pk_bf16_f32 v86, v89, v90
    v_and_b32 v66, 0xffff, v86
    v_lshrrev_b32 v67, 16, v86
    v_sub_f32 v68, v68, v80
    v_sub_f32 v69, v69, v80
    v_cvt_pk_bf16_f32 v86, v68, v69
    v_lshlrev_b32 v68, 16, v86
    v_and_b32 v69, 0xffff0000, v86
    v_mul_f32 v89, v68, v87
    v_mul_f32 v90, v69, v87
    v_fma_f32 v91, -v89, v84, v68
    v_fma_f32 v92, -v90, v84, v69
    v_fmac_f32 v89, v91, v87
    v_fmac_f32 v90, v92, v87
    v_cvt_pk_bf16_f32 v86, v89, v90
    v_and_b32 v68, 0xffff, v86
    v_lshrrev_b32 v69, 16, v86
    v_sub_f32 v70, v70, v80
    v_sub_f32 v71, v71, v80
    v_cvt_pk_bf16_f32 v86, v70, v71
    v_lshlrev_b32 v70, 16, v86
    v_and_b32 v71, 0xffff0000, v86
    v_mul_f32 v89, v70, v87
    v_mul_f32 v90, v71, v87
    v_fma_f32 v91, -v89, v84, v70
    v_fma_f32 v92, -v90, v84, v71
    v_fmac_f32 v89, v91, v87
    v_fmac_f32 v90, v92, v87
    v_cvt_pk_bf16_f32 v86, v89, v90
    v_and_b32 v70, 0xffff, v86
    v_lshrrev_b32 v71, 16, v86
    v_lshlrev_b32 v12, 5, v1
    v_add_u32 v12, 131328, v12
    ds_write_b128 v12, v[64:67]
    ds_write_b128 v12, v[68:71] offset:16
    v_lshlrev_b32 v13, 5, v5
    v_add_u32 v13, 131328, v13
    s_waitcnt lgkmcnt(0)
    ds_read_b128 v[64:67], v13
    ds_read_b128 v[68:71], v13 offset:16
    v_mov_b32 v96, 0
    v_mov_b32 v97, 0
    v_mov_b32 v98, 0
    v_mov_b32 v99, 0
    v_mov_b32 v100, 0
    v_mov_b32 v101, 0
    v_mov_b32 v102, 0
    v_mov_b32 v103, 0
    s_waitcnt lgkmcnt(0)
    v_lshlrev_b32 v72, 16, v64
    v_lshlrev_b32 v73, 16, v65
    v_lshlrev_b32 v74, 16, v66
    v_lshlrev_b32 v75, 16, v67
    v_lshlrev_b32 v76, 16, v68
    v_lshlrev_b32 v77, 16, v69
    v_lshlrev_b32 v78, 16, v70
    v_lshlrev_b32 v79, 16, v71
    s_waitcnt vmcnt(0)
    v_dot2_f32_bf16 v96, v32, v64, v96
    v_dot2_f32_bf16 v97, v32, v72, v97
    v_dot2_f32_bf16 v98, v33, v64, v98
    v_dot2_f32_bf16 v99, v33, v72, v99
    v_dot2_f32_bf16 v100, v34, v64, v100
    v_dot2_f32_bf16 v101, v34, v72, v101
    v_dot2_f32_bf16 v102, v35, v64, v102
    v_dot2_f32_bf16 v103, v35, v72, v103
    v_dot2_f32_bf16 v96, v36, v65, v96
    v_dot2_f32_bf16 v97, v36, v73, v97
    v_dot2_f32_bf16 v98, v37, v65, v98
    v_dot2_f32_bf16 v99, v37, v73, v99
    v_dot2_f32_bf16 v100, v38, v65, v100
    v_dot2_f32_bf16 v101, v38, v73, v101
    v_dot2_f32_bf16 v102, v39, v65, v102
    v_dot2_f32_bf16 v103, v39, v73, v103
    v_dot2_f32_bf16 v96, v40, v66, v96
    v_dot2_f32_bf16 v97, v40, v74, v97
    v_dot2_f32_bf16 v98, v41, v66, v98
    v_dot2_f32_bf16 v99, v41, v74, v99
    v_dot2_f32_bf16 v100, v42, v66, v100
    v_dot2_f32_bf16 v101, v42, v74, v101
    v_dot2_f32_bf16 v102, v43, v66, v102
    v_dot2_f32_bf16 v103, v43, v74, v103
    v_dot2_f32_bf16 v96, v44, v67, v96
    v_dot2_f32_bf16 v97, v44, v75, v97
    v_dot2_f32_bf16 v98, v45, v67, v98
    v_dot2_f32_bf16 v99, v45, v75, v99
    v_dot2_f32_bf16 v100, v46, v67, v100
    v_dot2_f32_bf16 v101, v46, v75, v101
    v_dot2_f32_bf16 v102, v47, v67, v102
    v_dot2_f32_bf16 v103, v47, v75, v103
    v_dot2_f32_bf16 v96, v48, v68, v96
    v_dot2_f32_bf16 v97, v48, v76, v97
    v_dot2_f32_bf16 v98, v49, v68, v98
    v_dot2_f32_bf16 v99, v49, v76, v99
    v_dot2_f32_bf16 v100, v50, v68, v100
    v_dot2_f32_bf16 v101, v50, v76, v101
    v_dot2_f32_bf16 v102, v51, v68, v102
    v_dot2_f32_bf16 v103, v51, v76, v103
    v_dot2_f32_bf16 v96, v52, v69, v96
    v_dot2_f32_bf16 v97, v52, v77, v97
    v_dot2_f32_bf16 v98, v53, v69, v98
    v_dot2_f32_bf16 v99, v53, v77, v99
    v_dot2_f32_bf16 v100, v54, v69, v100
    v_dot2_f32_bf16 v101, v54, v77, v101
    v_dot2_f32_bf16 v102, v55, v69, v102
    v_dot2_f32_bf16 v103, v55, v77, v103
    v_dot2_f32_bf16 v96, v56, v70, v96
    v_dot2_f32_bf16 v97, v56, v78, v97
    v_dot2_f32_bf16 v98, v57, v70, v98
    v_dot2_f32_bf16 v99, v57, v78, v99
    v_dot2_f32_bf16 v100, v58, v70, v100
    v_dot2_f32_bf16 v101, v58, v78, v101
    v_dot2_f32_bf16 v102, v59, v70, v102
    v_dot2_f32_bf16 v103, v59, v78, v103
    v_dot2_f32_bf16 v96, v60, v71, v96
    v_dot2_f32_bf16 v97, v60, v79, v97
    v_dot2_f32_bf16 v98, v61, v71, v98
    v_dot2_f32_bf16 v99, v61, v79, v99
    v_dot2_f32_bf16 v100, v62, v71, v100
    v_dot2_f32_bf16 v101, v62, v79, v101
    v_dot2_f32_bf16 v102, v63, v71, v102
    v_dot2_f32_bf16 v103, v63, v79, v103
    s_nop 3
    s_nop 1
    v_permlane32_swap_b32 v96, v100
    v_permlane32_swap_b32 v97, v101
    v_permlane32_swap_b32 v98, v102
    v_permlane32_swap_b32 v99, v103
    s_nop 0
    v_add_f32 v96, v96, v100
    v_add_f32 v97, v97, v101
    v_add_f32 v98, v98, v102
    v_add_f32 v99, v99, v103
    s_nop 1
    v_permlane16_swap_b32 v96, v98
    v_permlane16_swap_b32 v97, v99
    s_nop 0
    v_add_f32 v96, v96, v98
    v_add_f32 v97, v97, v99
    s_nop 1
    v_add_f32_dpp v96, v96, v96 row_ror:4 row_mask:0xf bank_mask:0xf
    v_add_f32_dpp v97, v97, v97 row_ror:4 row_mask:0xf bank_mask:0xf
    s_nop 1
    v_add_f32_dpp v96, v96, v96 row_ror:8 row_mask:0xf bank_mask:0xf
    v_add_f32_dpp v97, v97, v97 row_ror:8 row_mask:0xf bank_mask:0xf
    v_lshlrev_b32 v12, 5, v6
    v_lshl_add_u32 v12, v3, 3, v12
    s_lshl_b32 s33, s28, 7
    s_add_u32 s33, s33, 133376
    v_add_u32 v12, s33, v12
    v_and_b32 v13, 12, v1
    v_cmp_eq_u32 vcc, 0, v13
    s_and_saveexec_b64 s[64:65], vcc
    ds_write_b64 v12, v[96:97]
    s_mov_b64 exec, s[64:65]
    s_waitcnt lgkmcnt(0)
    v_cmp_eq_u32 vcc, 0, v1
    s_and_saveexec_b64 s[64:65], vcc
    ds_add_u32 v14, v15 offset:32
    s_mov_b64 exec, s[64:65]
C_pre:
    s_setprio 2
    s_lshl_b32 s33, s28, 14
    v_and_b32 v145, 7, v2
    v_lshlrev_b32 v145, 1, v145
    v_xor_b32 v145, v3, v145
    v_lshlrev_b32 v145, 4, v145
    v_lshl_add_u32 v145, v2, 8, v145
    v_add_u32 v160, s33, v145
    v_xor_b32 v161, 64, v160
    v_xor_b32 v162, 128, v160
    v_xor_b32 v163, 192, v160
    v_add_u32 v164, 0x10000, v160
    v_add_u32 v165, 0x10000, v161
    v_add_u32 v166, 0x10000, v162
    v_add_u32 v167, 0x10000, v163
    v_bfe_u32 v145, v1, 2, 2
    v_lshl_add_u32 v145, v3, 2, v145
    v_and_b32 v146, 7, v145
    v_lshlrev_b32 v146, 1, v146
    v_bfe_u32 v147, v1, 1, 1
    v_xor_b32 v146, v146, v147
    v_lshlrev_b32 v146, 4, v146
    v_lshl_add_u32 v146, v145, 8, v146
    v_and_b32 v147, 1, v1
    v_lshl_add_u32 v146, v147, 3, v146
    v_add_u32 v146, 8192, v146
    v_add_u32 v168, s33, v146
    v_xor_b32 v169, 32, v168
    v_xor_b32 v170, 64, v168
    v_xor_b32 v171, 96, v168
    v_xor_b32 v172, 128, v168
    v_xor_b32 v173, 160, v168
    v_xor_b32 v174, 192, v168
    v_xor_b32 v175, 224, v168
    v_add_u32 v176, 0x10000, v168
    v_add_u32 v177, 0x10000, v169
    v_add_u32 v178, 0x10000, v170
    v_add_u32 v179, 0x10000, v171
    v_add_u32 v180, 0x10000, v172
    v_add_u32 v181, 0x10000, v173
    v_add_u32 v182, 0x10000, v174
    v_add_u32 v183, 0x10000, v175
    v_mov_b32 v96, 0
    v_mov_b32 v97, 0
    v_mov_b32 v98, 0
    v_mov_b32 v99, 0
    v_mov_b32 v100, 0
    v_mov_b32 v101, 0
    v_mov_b32 v102, 0
    v_mov_b32 v103, 0
    v_mov_b32 v104, 0
    v_mov_b32 v105, 0
    v_mov_b32 v106, 0
    v_mov_b32 v107, 0
    v_mov_b32 v108, 0
    v_mov_b32 v109, 0
    v_mov_b32 v110, 0
    v_mov_b32 v111, 0
    v_mov_b32 v112, 0
    v_mov_b32 v113, 0
    v_mov_b32 v114, 0
    v_mov_b32 v115, 0
    v_mov_b32 v116, 0
    v_mov_b32 v117, 0
    v_mov_b32 v118, 0
    v_mov_b32 v119, 0
    v_mov_b32 v120, 0
    v_mov_b32 v121, 0
    v_mov_b32 v122, 0
    v_mov_b32 v123, 0
    v_mov_b32 v124, 0
    v_mov_b32 v125, 0
    v_mov_b32 v126, 0
    v_mov_b32 v127, 0
    v_mov_b32 v140, 0xff800000
    v_mov_b32 v141, 0
    s_lshl_b32 s66, s28, 1
    s_add_u32 s66, s66, 1
    s_mov_b32 s67, 0
    s_lshl_b32 s33, s28, 2
    s_add_u32 s33, s33, 131088
    v_mov_b32 v150, s33
    s_mov_b32 s68, 0
    s_cmp_ge_u32 s68, s66
    s_cbranch_scc1 CK_1
    s_mov_b32 s82, 0
CW_2:
    ds_read_b64 v[144:145], v14 offset:0
    s_waitcnt lgkmcnt(0)
    v_readfirstlane_b32 s68, v144
    v_readfirstlane_b32 s33, v145
    s_add_u32 s82, s82, 1
    s_cmp_ge_u32 s68, s66
    s_cbranch_scc1 CK_1
    s_sub_u32 s33, s33, 1
    s_cmp_lt_u32 s33, s66
    s_cbranch_scc1 C_done
    s_sleep 1
    s_cmp_lt_u32 s82, 0x800000
    s_cbranch_scc1 CW_2
CK_1:
    ds_read_b128 v[32:35], v160 offset:0
    ds_read_b128 v[36:39], v161 offset:0
    ds_read_b128 v[40:43], v162 offset:0
    ds_read_b128 v[44:47], v163 offset:0
    ds_read_b128 v[48:51], v160 offset:4096
    ds_read_b128 v[52:55], v161 offset:4096
    ds_read_b128 v[56:59], v162 offset:4096
    ds_read_b128 v[60:63], v163 offset:4096
    s_add_u32 s66, s66, 1
    s_cmp_ge_u32 s68, s66
    s_cbranch_scc1 CV_3
    s_mov_b32 s82, 0
LW_4:
    ds_read_b32 v144, v14 offset:0
    s_waitcnt lgkmcnt(0)
    v_readfirstlane_b32 s68, v144
    s_add_u32 s82, s82, 1
    s_cmp_ge_u32 s68, s66
    s_cbranch_scc1 LG_5
    s_sleep 1
    s_cmp_lt_u32 s82, 0x800000
    s_cbranch_scc1 LW_4
LG_5:
CV_3:
    s_waitcnt lgkmcnt(4)
    ds_read_b64_tr_b16 v[64:65], v168 offset:0
    ds_read_b64_tr_b16 v[66:67], v168 offset:4096
    ds_read_b64_tr_b16 v[68:69], v169 offset:0
    ds_read_b64_tr_b16 v[70:71], v169 offset:4096
    ds_read_b64_tr_b16 v[72:73], v170 offset:0
    ds_read_b64_tr_b16 v[74:75], v170 offset:4096
    s_waitcnt lgkmcnt(4)
    ds_read_b64_tr_b16 v[76:77], v171 offset:0
    ds_read_b64_tr_b16 v[78:79], v171 offset:4096
    ds_read_b64_tr_b16 v[80:81], v172 offset:0
    ds_read_b64_tr_b16 v[82:83], v172 offset:4096
    ds_read_b64_tr_b16 v[84:85], v173 offset:0
    ds_read_b64_tr_b16 v[86:87], v173 offset:4096
    s_waitcnt lgkmcnt(4)
    ds_read_b64_tr_b16 v[88:89], v174 offset:0
    ds_read_b64_tr_b16 v[90:91], v174 offset:4096
    ds_read_b64_tr_b16 v[92:93], v175 offset:0
    ds_read_b64_tr_b16 v[94:95], v175 offset:4096
    s_add_u32 s67, s67, 1
    v_mov_b32 v151, s67
    s_add_u32 s66, s66, 7
    s_waitcnt lgkmcnt(0)
    ds_write_b32 v150, v151
    s_cmp_ge_u32 s68, s66
    s_cbranch_scc1 CK_6
    s_mov_b32 s82, 0
CW_7:
    ds_read_b64 v[144:145], v14 offset:0
    s_waitcnt lgkmcnt(0)
    v_readfirstlane_b32 s68, v144
    v_readfirstlane_b32 s33, v145
    s_add_u32 s82, s82, 1
    s_cmp_ge_u32 s68, s66
    s_cbranch_scc1 CK_6
    s_sub_u32 s33, s33, 1
    s_cmp_lt_u32 s33, s66
    s_cbranch_scc1 C_done
    s_sleep 1
    s_cmp_lt_u32 s82, 0x800000
    s_cbranch_scc1 CW_7
CK_6:
    ds_read_b128 v[184:187], v164 offset:0
    ds_read_b128 v[188:191], v165 offset:0
    ds_read_b128 v[192:195], v166 offset:0
    ds_read_b128 v[196:199], v167 offset:0
    ds_read_b128 v[200:203], v164 offset:4096
    ds_read_b128 v[204:207], v165 offset:4096
    ds_read_b128 v[208:211], v166 offset:4096
    ds_read_b128 v[212:215], v167 offset:4096
    s_add_u32 s66, s66, 1
    s_cmp_ge_u32 s68, s66
    s_cbranch_scc1 CV_8
    s_mov_b32 s82, 0
LW_9:
    ds_read_b32 v144, v14 offset:0
    s_waitcnt lgkmcnt(0)
    v_readfirstlane_b32 s68, v144
    s_add_u32 s82, s82, 1
    s_cmp_ge_u32 s68, s66
    s_cbranch_scc1 LG_10
    s_sleep 1
    s_cmp_lt_u32 s82, 0x800000
    s_cbranch_scc1 LW_9
LG_10:
CV_8:
    s_waitcnt lgkmcnt(4)
    ds_read_b64_tr_b16 v[216:217], v176 offset:0
    ds_read_b64_tr_b16 v[218:219], v176 offset:4096
    ds_read_b64_tr_b16 v[220:221], v177 offset:0
    ds_read_b64_tr_b16 v[222:223], v177 offset:4096
    ds_read_b64_tr_b16 v[224:225], v178 offset:0
    ds_read_b64_tr_b16 v[226:227], v178 offset:4096
    s_waitcnt lgkmcnt(4)
    ds_read_b64_tr_b16 v[228:229], v179 offset:0
    ds_read_b64_tr_b16 v[230:231], v179 offset:4096
    ds_read_b64_tr_b16 v[232:233], v180 offset:0
    ds_read_b64_tr_b16 v[234:235], v180 offset:4096
    ds_read_b64_tr_b16 v[236:237], v181 offset:0
    ds_read_b64_tr_b16 v[238:239], v181 offset:4096
    s_waitcnt lgkmcnt(4)
    ds_read_b64_tr_b16 v[240:241], v182 offset:0
    ds_read_b64_tr_b16 v[242:243], v182 offset:4096
    ds_read_b64_tr_b16 v[244:245], v183 offset:0
    ds_read_b64_tr_b16 v[246:247], v183 offset:4096
    s_add_u32 s67, s67, 1
    v_mov_b32 v151, s67
    s_add_u32 s66, s66, 7
    s_waitcnt lgkmcnt(0)
    ds_write_b32 v150, v151
    s_mov_b32 s82, 0
LW_11:
    ds_read_b32 v144, v14 offset:36
    s_waitcnt lgkmcnt(0)
    v_readfirstlane_b32 s33, v144
    s_add_u32 s82, s82, 1
    s_cmp_ge_u32 s33, 1
    s_cbranch_scc1 LG_12
    s_sleep 1
    s_cmp_lt_u32 s82, 0x800000
    s_cbranch_scc1 LW_11
LG_12:
    v_mov_b32 v16, 0
    v_mov_b32 v17, 0
    v_mov_b32 v18, 0
    v_mov_b32 v19, 0
    v_mov_b32 v20, 0
    v_mov_b32 v21, 0
    v_mov_b32 v22, 0
    v_mov_b32 v23, 0
    v_mov_b32 v24, 0
    v_mov_b32 v25, 0
    v_mov_b32 v26, 0
    v_mov_b32 v27, 0
    v_mov_b32 v28, 0
    v_mov_b32 v29, 0
    v_mov_b32 v30, 0
    v_mov_b32 v31, 0
    v_lshlrev_b32 v12, 8, v2
    v_lshl_add_u32 v12, v3, 4, v12
    v_add_u32 v12, 134144, v12
    v_cmp_gt_u32 vcc, 4, v2
    s_and_saveexec_b64 s[64:65], vcc
    ds_read_b128 v[16:19], v12 offset:0
    ds_read_b128 v[20:23], v12 offset:64
    ds_read_b128 v[24:27], v12 offset:128
    ds_read_b128 v[28:31], v12 offset:192
    s_mov_b64 exec, s[64:65]
    s_waitcnt lgkmcnt(0)
    v_mfma_f32_16x16x32_bf16 v[128:131], v[32:35], v[16:19], 0
    v_mfma_f32_16x16x32_bf16 v[132:135], v[48:51], v[16:19], 0
    v_mfma_f32_16x16x32_bf16 v[128:131], v[36:39], v[20:23], v[128:131]
    v_mfma_f32_16x16x32_bf16 v[132:135], v[52:55], v[20:23], v[132:135]
    v_mfma_f32_16x16x32_bf16 v[128:131], v[40:43], v[24:27], v[128:131]
    v_mfma_f32_16x16x32_bf16 v[132:135], v[56:59], v[24:27], v[132:135]
    v_mfma_f32_16x16x32_bf16 v[128:131], v[44:47], v[28:31], v[128:131]
    v_mfma_f32_16x16x32_bf16 v[132:135], v[60:63], v[28:31], v[132:135]
    s_nop 7
    s_nop 1
    v_cvt_pk_bf16_f32 v152, v128, v129
    v_lshlrev_b32 v128, 16, v152
    v_and_b32 v129, 0xffff0000, v152
    v_cvt_pk_bf16_f32 v153, v130, v131
    v_lshlrev_b32 v130, 16, v153
    v_and_b32 v131, 0xffff0000, v153
    v_cvt_pk_bf16_f32 v154, v132, v133
    v_lshlrev_b32 v132, 16, v154
    v_and_b32 v133, 0xffff0000, v154
    v_cvt_pk_bf16_f32 v155, v134, v135
    v_lshlrev_b32 v134, 16, v155
    v_and_b32 v135, 0xffff0000, v155
    v_mul_f32 v128, s61, v128
    v_mul_f32 v129, s61, v129
    v_mul_f32 v130, s61, v130
    v_mul_f32 v131, s61, v131
    v_mul_f32 v132, s61, v132
    v_mul_f32 v133, s61, v133
    v_mul_f32 v134, s61, v134
    v_mul_f32 v135, s61, v135
    v_cvt_pk_bf16_f32 v152, v128, v129
    v_lshlrev_b32 v128, 16, v152
    v_and_b32 v129, 0xffff0000, v152
    v_cvt_pk_bf16_f32 v153, v130, v131
    v_lshlrev_b32 v130, 16, v153
    v_and_b32 v131, 0xffff0000, v153
    v_cvt_pk_bf16_f32 v154, v132, v133
    v_lshlrev_b32 v132, 16, v154
    v_and_b32 v133, 0xffff0000, v154
    v_cvt_pk_bf16_f32 v155, v134, v135
    v_lshlrev_b32 v134, 16, v155
    v_and_b32 v135, 0xffff0000, v155
    v_max3_f32 v144, v128, v129, v130
    v_max3_f32 v145, v131, v132, v133
    v_max3_f32 v144, v144, v134, v135
    v_max_f32 v144, v144, v145
    v_mov_b32 v145, v144
    s_nop 1
    v_permlane16_swap_b32 v144, v145
    s_nop 0
    v_max_f32 v144, v144, v145
    v_mov_b32 v145, v144
    s_nop 1
    v_permlane32_swap_b32 v144, v145
    s_nop 0
    v_max_f32 v144, v144, v145
    v_max_f32 v144, v144, v140
    v_sub_f32 v145, v140, v144
    v_mul_f32 v145, s60, v145
    v_exp_f32 v145, v145
    v_mov_b32 v140, v144
    v_mul_f32 v146, s60, v144
    v_fma_f32 v128, v128, s60, -v146
    v_fma_f32 v129, v129, s60, -v146
    v_fma_f32 v130, v130, s60, -v146
    v_fma_f32 v131, v131, s60, -v146
    v_fma_f32 v132, v132, s60, -v146
    v_fma_f32 v133, v133, s60, -v146
    v_fma_f32 v134, v134, s60, -v146
    v_fma_f32 v135, v135, s60, -v146
    v_exp_f32 v128, v128
    v_exp_f32 v129, v129
    v_exp_f32 v130, v130
    v_exp_f32 v131, v131
    v_exp_f32 v132, v132
    v_exp_f32 v133, v133
    v_exp_f32 v134, v134
    v_exp_f32 v135, v135
    v_mul_f32 v141, v141, v145
    v_add_f32 v141, v141, v128
    v_add_f32 v141, v141, v129
    v_add_f32 v141, v141, v130
    v_add_f32 v141, v141, v131
    v_add_f32 v141, v141, v132
    v_add_f32 v141, v141, v133
    v_add_f32 v141, v141, v134
    v_add_f32 v141, v141, v135
    v_cvt_pk_bf16_f32 v136, v128, v129
    v_cvt_pk_bf16_f32 v137, v130, v131
    v_cvt_pk_bf16_f32 v138, v132, v133
    v_cvt_pk_bf16_f32 v139, v134, v135
    v_mul_f32 v96, v96, v145
    v_mul_f32 v97, v97, v145
    v_mul_f32 v98, v98, v145
    v_mul_f32 v99, v99, v145
    v_mul_f32 v100, v100, v145
    v_mul_f32 v101, v101, v145
    v_mul_f32 v102, v102, v145
    v_mul_f32 v103, v103, v145
    v_mul_f32 v104, v104, v145
    v_mul_f32 v105, v105, v145
    v_mul_f32 v106, v106, v145
    v_mul_f32 v107, v107, v145
    v_mul_f32 v108, v108, v145
    v_mul_f32 v109, v109, v145
    v_mul_f32 v110, v110, v145
    v_mul_f32 v111, v111, v145
    v_mul_f32 v112, v112, v145
    v_mul_f32 v113, v113, v145
    v_mul_f32 v114, v114, v145
    v_mul_f32 v115, v115, v145
    v_mul_f32 v116, v116, v145
    v_mul_f32 v117, v117, v145
    v_mul_f32 v118, v118, v145
    v_mul_f32 v119, v119, v145
    v_mul_f32 v120, v120, v145
    v_mul_f32 v121, v121, v145
    v_mul_f32 v122, v122, v145
    v_mul_f32 v123, v123, v145
    v_mul_f32 v124, v124, v145
    v_mul_f32 v125, v125, v145
    v_mul_f32 v126, v126, v145
    v_mul_f32 v127, v127, v145
    s_nop 1
    v_mfma_f32_16x16x32_bf16 v[96:99], v[64:67], v[136:139], v[96:99]
    v_mfma_f32_16x16x32_bf16 v[100:103], v[68:71], v[136:139], v[100:103]
    v_mfma_f32_16x16x32_bf16 v[104:107], v[72:75], v[136:139], v[104:107]
    v_mfma_f32_16x16x32_bf16 v[108:111], v[76:79], v[136:139], v[108:111]
    v_mfma_f32_16x16x32_bf16 v[112:115], v[80:83], v[136:139], v[112:115]
    v_mfma_f32_16x16x32_bf16 v[116:119], v[84:87], v[136:139], v[116:119]
    v_mfma_f32_16x16x32_bf16 v[120:123], v[88:91], v[136:139], v[120:123]
    v_mfma_f32_16x16x32_bf16 v[124:127], v[92:95], v[136:139], v[124:127]
    s_nop 7
    s_nop 1
    s_branch C_mid
C_loop:
    s_cmp_ge_u32 s68, s66
    s_cbranch_scc1 CK_13
    s_mov_b32 s82, 0
CW_14:
    ds_read_b64 v[144:145], v14 offset:0
    s_waitcnt lgkmcnt(0)
    v_readfirstlane_b32 s68, v144
    v_readfirstlane_b32 s33, v145
    s_add_u32 s82, s82, 1
    s_cmp_ge_u32 s68, s66
    s_cbranch_scc1 CK_13
    s_sub_u32 s33, s33, 1
    s_cmp_lt_u32 s33, s66
    s_cbranch_scc1 C_done
    s_sleep 1
    s_cmp_lt_u32 s82, 0x800000
    s_cbranch_scc1 CW_14
CK_13:
    ds_read_b128 v[32:35], v160 offset:0
    ds_read_b128 v[36:39], v161 offset:0
    ds_read_b128 v[40:43], v162 offset:0
    ds_read_b128 v[44:47], v163 offset:0
    ds_read_b128 v[48:51], v160 offset:4096
    ds_read_b128 v[52:55], v161 offset:4096
    ds_read_b128 v[56:59], v162 offset:4096
    ds_read_b128 v[60:63], v163 offset:4096
    s_add_u32 s66, s66, 1
    s_cmp_ge_u32 s68, s66
    s_cbranch_scc1 CV_15
    s_mov_b32 s82, 0
LW_16:
    ds_read_b32 v144, v14 offset:0
    s_waitcnt lgkmcnt(0)
    v_readfirstlane_b32 s68, v144
    s_add_u32 s82, s82, 1
    s_cmp_ge_u32 s68, s66
    s_cbranch_scc1 LG_17
    s_sleep 1
    s_cmp_lt_u32 s82, 0x800000
    s_cbranch_scc1 LW_16
LG_17:
CV_15:
    s_waitcnt lgkmcnt(4)
    ds_read_b64_tr_b16 v[64:65], v168 offset:0
    ds_read_b64_tr_b16 v[66:67], v168 offset:4096
    ds_read_b64_tr_b16 v[68:69], v169 offset:0
    ds_read_b64_tr_b16 v[70:71], v169 offset:4096
    ds_read_b64_tr_b16 v[72:73], v170 offset:0
    ds_read_b64_tr_b16 v[74:75], v170 offset:4096
    s_waitcnt lgkmcnt(4)
    ds_read_b64_tr_b16 v[76:77], v171 offset:0
    ds_read_b64_tr_b16 v[78:79], v171 offset:4096
    ds_read_b64_tr_b16 v[80:81], v172 offset:0
    ds_read_b64_tr_b16 v[82:83], v172 offset:4096
    ds_read_b64_tr_b16 v[84:85], v173 offset:0
    ds_read_b64_tr_b16 v[86:87], v173 offset:4096
    s_waitcnt lgkmcnt(4)
    ds_read_b64_tr_b16 v[88:89], v174 offset:0
    ds_read_b64_tr_b16 v[90:91], v174 offset:4096
    ds_read_b64_tr_b16 v[92:93], v175 offset:0
    ds_read_b64_tr_b16 v[94:95], v175 offset:4096
    s_add_u32 s67, s67, 1
    v_mov_b32 v151, s67
    s_add_u32 s66, s66, 7
    s_waitcnt lgkmcnt(0)
    ds_write_b32 v150, v151
    v_mfma_f32_16x16x32_bf16 v[128:131], v[32:35], v[16:19], 0
    v_mfma_f32_16x16x32_bf16 v[132:135], v[48:51], v[16:19], 0
    v_mfma_f32_16x16x32_bf16 v[128:131], v[36:39], v[20:23], v[128:131]
    v_mfma_f32_16x16x32_bf16 v[132:135], v[52:55], v[20:23], v[132:135]
    v_mfma_f32_16x16x32_bf16 v[128:131], v[40:43], v[24:27], v[128:131]
    v_mfma_f32_16x16x32_bf16 v[132:135], v[56:59], v[24:27], v[132:135]
    v_mfma_f32_16x16x32_bf16 v[128:131], v[44:47], v[28:31], v[128:131]
    v_mfma_f32_16x16x32_bf16 v[132:135], v[60:63], v[28:31], v[132:135]
    s_nop 7
    s_nop 1
    v_cvt_pk_bf16_f32 v152, v128, v129
    v_lshlrev_b32 v128, 16, v152
    v_and_b32 v129, 0xffff0000, v152
    v_cvt_pk_bf16_f32 v153, v130, v131
    v_lshlrev_b32 v130, 16, v153
    v_and_b32 v131, 0xffff0000, v153
    v_cvt_pk_bf16_f32 v154, v132, v133
    v_lshlrev_b32 v132, 16, v154
    v_and_b32 v133, 0xffff0000, v154
    v_cvt_pk_bf16_f32 v155, v134, v135
    v_lshlrev_b32 v134, 16, v155
    v_and_b32 v135, 0xffff0000, v155
    v_mul_f32 v128, s61, v128
    v_mul_f32 v129, s61, v129
    v_mul_f32 v130, s61, v130
    v_mul_f32 v131, s61, v131
    v_mul_f32 v132, s61, v132
    v_mul_f32 v133, s61, v133
    v_mul_f32 v134, s61, v134
    v_mul_f32 v135, s61, v135
    v_cvt_pk_bf16_f32 v152, v128, v129
    v_lshlrev_b32 v128, 16, v152
    v_and_b32 v129, 0xffff0000, v152
    v_cvt_pk_bf16_f32 v153, v130, v131
    v_lshlrev_b32 v130, 16, v153
    v_and_b32 v131, 0xffff0000, v153
    v_cvt_pk_bf16_f32 v154, v132, v133
    v_lshlrev_b32 v132, 16, v154
    v_and_b32 v133, 0xffff0000, v154
    v_cvt_pk_bf16_f32 v155, v134, v135
    v_lshlrev_b32 v134, 16, v155
    v_and_b32 v135, 0xffff0000, v155
    v_max3_f32 v144, v128, v129, v130
    v_max3_f32 v145, v131, v132, v133
    v_max3_f32 v144, v144, v134, v135
    v_max_f32 v144, v144, v145
    v_mov_b32 v145, v144
    s_nop 1
    v_permlane16_swap_b32 v144, v145
    s_nop 0
    v_max_f32 v144, v144, v145
    v_mov_b32 v145, v144
    s_nop 1
    v_permlane32_swap_b32 v144, v145
    s_nop 0
    v_max_f32 v144, v144, v145
    v_max_f32 v144, v144, v140
    v_sub_f32 v145, v140, v144
    v_mul_f32 v145, s60, v145
    v_exp_f32 v145, v145
    v_mov_b32 v140, v144
    v_mul_f32 v146, s60, v144
    v_fma_f32 v128, v128, s60, -v146
    v_fma_f32 v129, v129, s60, -v146
    v_fma_f32 v130, v130, s60, -v146
    v_fma_f32 v131, v131, s60, -v146
    v_fma_f32 v132, v132, s60, -v146
    v_fma_f32 v133, v133, s60, -v146
    v_fma_f32 v134, v134, s60, -v146
    v_fma_f32 v135, v135, s60, -v146
    v_exp_f32 v128, v128
    v_exp_f32 v129, v129
    v_exp_f32 v130, v130
    v_exp_f32 v131, v131
    v_exp_f32 v132, v132
    v_exp_f32 v133, v133
    v_exp_f32 v134, v134
    v_exp_f32 v135, v135
    v_mul_f32 v141, v141, v145
    v_add_f32 v141, v141, v128
    v_add_f32 v141, v141, v129
    v_add_f32 v141, v141, v130
    v_add_f32 v141, v141, v131
    v_add_f32 v141, v141, v132
    v_add_f32 v141, v141, v133
    v_add_f32 v141, v141, v134
    v_add_f32 v141, v141, v135
    v_cvt_pk_bf16_f32 v136, v128, v129
    v_cvt_pk_bf16_f32 v137, v130, v131
    v_cvt_pk_bf16_f32 v138, v132, v133
    v_cvt_pk_bf16_f32 v139, v134, v135
    v_mul_f32 v96, v96, v145
    v_mul_f32 v97, v97, v145
    v_mul_f32 v98, v98, v145
    v_mul_f32 v99, v99, v145
    v_mul_f32 v100, v100, v145
    v_mul_f32 v101, v101, v145
    v_mul_f32 v102, v102, v145
    v_mul_f32 v103, v103, v145
    v_mul_f32 v104, v104, v145
    v_mul_f32 v105, v105, v145
    v_mul_f32 v106, v106, v145
    v_mul_f32 v107, v107, v145
    v_mul_f32 v108, v108, v145
    v_mul_f32 v109, v109, v145
    v_mul_f32 v110, v110, v145
    v_mul_f32 v111, v111, v145
    v_mul_f32 v112, v112, v145
    v_mul_f32 v113, v113, v145
    v_mul_f32 v114, v114, v145
    v_mul_f32 v115, v115, v145
    v_mul_f32 v116, v116, v145
    v_mul_f32 v117, v117, v145
    v_mul_f32 v118, v118, v145
    v_mul_f32 v119, v119, v145
    v_mul_f32 v120, v120, v145
    v_mul_f32 v121, v121, v145
    v_mul_f32 v122, v122, v145
    v_mul_f32 v123, v123, v145
    v_mul_f32 v124, v124, v145
    v_mul_f32 v125, v125, v145
    v_mul_f32 v126, v126, v145
    v_mul_f32 v127, v127, v145
    s_nop 1
    v_mfma_f32_16x16x32_bf16 v[96:99], v[64:67], v[136:139], v[96:99]
    v_mfma_f32_16x16x32_bf16 v[100:103], v[68:71], v[136:139], v[100:103]
    v_mfma_f32_16x16x32_bf16 v[104:107], v[72:75], v[136:139], v[104:107]
    v_mfma_f32_16x16x32_bf16 v[108:111], v[76:79], v[136:139], v[108:111]
    v_mfma_f32_16x16x32_bf16 v[112:115], v[80:83], v[136:139], v[112:115]
    v_mfma_f32_16x16x32_bf16 v[116:119], v[84:87], v[136:139], v[116:119]
    v_mfma_f32_16x16x32_bf16 v[120:123], v[88:91], v[136:139], v[120:123]
    v_mfma_f32_16x16x32_bf16 v[124:127], v[92:95], v[136:139], v[124:127]
    s_nop 7
    s_nop 1
    s_cmp_ge_u32 s68, s66
    s_cbranch_scc1 CK_18
    s_mov_b32 s82, 0
CW_19:
    ds_read_b64 v[144:145], v14 offset:0
    s_waitcnt lgkmcnt(0)
    v_readfirstlane_b32 s68, v144
    v_readfirstlane_b32 s33, v145
    s_add_u32 s82, s82, 1
    s_cmp_ge_u32 s68, s66
    s_cbranch_scc1 CK_18
    s_sub_u32 s33, s33, 1
    s_cmp_lt_u32 s33, s66
    s_cbranch_scc1 C_done
    s_sleep 1
    s_cmp_lt_u32 s82, 0x800000
    s_cbranch_scc1 CW_19
CK_18:
    ds_read_b128 v[184:187], v164 offset:0
    ds_read_b128 v[188:191], v165 offset:0
    ds_read_b128 v[192:195], v166 offset:0
    ds_read_b128 v[196:199], v167 offset:0
    ds_read_b128 v[200:203], v164 offset:4096
    ds_read_b128 v[204:207], v165 offset:4096
    ds_read_b128 v[208:211], v166 offset:4096
    ds_read_b128 v[212:215], v167 offset:4096
    s_add_u32 s66, s66, 1
    s_cmp_ge_u32 s68, s66
    s_cbranch_scc1 CV_20
    s_mov_b32 s82, 0
LW_21:
    ds_read_b32 v144, v14 offset:0
    s_waitcnt lgkmcnt(0)
    v_readfirstlane_b32 s68, v144
    s_add_u32 s82, s82, 1
    s_cmp_ge_u32 s68, s66
    s_cbranch_scc1 LG_22
    s_sleep 1
    s_cmp_lt_u32 s82, 0x800000
    s_cbranch_scc1 LW_21
LG_22:
CV_20:
    s_waitcnt lgkmcnt(4)
    ds_read_b64_tr_b16 v[216:217], v176 offset:0
    ds_read_b64_tr_b16 v[218:219], v176 offset:4096
    ds_read_b64_tr_b16 v[220:221], v177 offset:0
    ds_read_b64_tr_b16 v[222:223], v177 offset:4096
    ds_read_b64_tr_b16 v[224:225], v178 offset:0
    ds_read_b64_tr_b16 v[226:227], v178 offset:4096
    s_waitcnt lgkmcnt(4)
    ds_read_b64_tr_b16 v[228:229], v179 offset:0
    ds_read_b64_tr_b16 v[230:231], v179 offset:4096
    ds_read_b64_tr_b16 v[232:233], v180 offset:0
    ds_read_b64_tr_b16 v[234:235], v180 offset:4096
    ds_read_b64_tr_b16 v[236:237], v181 offset:0
    ds_read_b64_tr_b16 v[238:239], v181 offset:4096
    s_waitcnt lgkmcnt(4)
    ds_read_b64_tr_b16 v[240:241], v182 offset:0
    ds_read_b64_tr_b16 v[242:243], v182 offset:4096
    ds_read_b64_tr_b16 v[244:245], v183 offset:0
    ds_read_b64_tr_b16 v[246:247], v183 offset:4096
    s_add_u32 s67, s67, 1
    v_mov_b32 v151, s67
    s_add_u32 s66, s66, 7
    s_waitcnt lgkmcnt(0)
    ds_write_b32 v150, v151
C_mid:
    v_mfma_f32_16x16x32_bf16 v[128:131], v[184:187], v[16:19], 0
    v_mfma_f32_16x16x32_bf16 v[132:135], v[200:203], v[16:19], 0
    v_mfma_f32_16x16x32_bf16 v[128:131], v[188:191], v[20:23], v[128:131]
    v_mfma_f32_16x16x32_bf16 v[132:135], v[204:207], v[20:23], v[132:135]
    v_mfma_f32_16x16x32_bf16 v[128:131], v[192:195], v[24:27], v[128:131]
    v_mfma_f32_16x16x32_bf16 v[132:135], v[208:211], v[24:27], v[132:135]
    v_mfma_f32_16x16x32_bf16 v[128:131], v[196:199], v[28:31], v[128:131]
    v_mfma_f32_16x16x32_bf16 v[132:135], v[212:215], v[28:31], v[132:135]
    s_nop 7
    s_nop 1
    v_cvt_pk_bf16_f32 v152, v128, v129
    v_lshlrev_b32 v128, 16, v152
    v_and_b32 v129, 0xffff0000, v152
    v_cvt_pk_bf16_f32 v153, v130, v131
    v_lshlrev_b32 v130, 16, v153
    v_and_b32 v131, 0xffff0000, v153
    v_cvt_pk_bf16_f32 v154, v132, v133
    v_lshlrev_b32 v132, 16, v154
    v_and_b32 v133, 0xffff0000, v154
    v_cvt_pk_bf16_f32 v155, v134, v135
    v_lshlrev_b32 v134, 16, v155
    v_and_b32 v135, 0xffff0000, v155
    v_mul_f32 v128, s61, v128
    v_mul_f32 v129, s61, v129
    v_mul_f32 v130, s61, v130
    v_mul_f32 v131, s61, v131
    v_mul_f32 v132, s61, v132
    v_mul_f32 v133, s61, v133
    v_mul_f32 v134, s61, v134
    v_mul_f32 v135, s61, v135
    v_cvt_pk_bf16_f32 v152, v128, v129
    v_lshlrev_b32 v128, 16, v152
    v_and_b32 v129, 0xffff0000, v152
    v_cvt_pk_bf16_f32 v153, v130, v131
    v_lshlrev_b32 v130, 16, v153
    v_and_b32 v131, 0xffff0000, v153
    v_cvt_pk_bf16_f32 v154, v132, v133
    v_lshlrev_b32 v132, 16, v154
    v_and_b32 v133, 0xffff0000, v154
    v_cvt_pk_bf16_f32 v155, v134, v135
    v_lshlrev_b32 v134, 16, v155
    v_and_b32 v135, 0xffff0000, v155
    v_max3_f32 v144, v128, v129, v130
    v_max3_f32 v145, v131, v132, v133
    v_max3_f32 v144, v144, v134, v135
    v_max_f32 v144, v144, v145
    v_mov_b32 v145, v144
    s_nop 1
    v_permlane16_swap_b32 v144, v145
    s_nop 0
    v_max_f32 v144, v144, v145
    v_mov_b32 v145, v144
    s_nop 1
    v_permlane32_swap_b32 v144, v145
    s_nop 0
    v_max_f32 v144, v144, v145
    v_max_f32 v144, v144, v140
    v_sub_f32 v145, v140, v144
    v_mul_f32 v145, s60, v145
    v_exp_f32 v145, v145
    v_mov_b32 v140, v144
    v_mul_f32 v146, s60, v144
    v_fma_f32 v128, v128, s60, -v146
    v_fma_f32 v129, v129, s60, -v146
    v_fma_f32 v130, v130, s60, -v146
    v_fma_f32 v131, v131, s60, -v146
    v_fma_f32 v132, v132, s60, -v146
    v_fma_f32 v133, v133, s60, -v146
    v_fma_f32 v134, v134, s60, -v146
    v_fma_f32 v135, v135, s60, -v146
    v_exp_f32 v128, v128
    v_exp_f32 v129, v129
    v_exp_f32 v130, v130
    v_exp_f32 v131, v131
    v_exp_f32 v132, v132
    v_exp_f32 v133, v133
    v_exp_f32 v134, v134
    v_exp_f32 v135, v135
    v_mul_f32 v141, v141, v145
    v_add_f32 v141, v141, v128
    v_add_f32 v141, v141, v129
    v_add_f32 v141, v141, v130
    v_add_f32 v141, v141, v131
    v_add_f32 v141, v141, v132
    v_add_f32 v141, v141, v133
    v_add_f32 v141, v141, v134
    v_add_f32 v141, v141, v135
    v_cvt_pk_bf16_f32 v136, v128, v129
    v_cvt_pk_bf16_f32 v137, v130, v131
    v_cvt_pk_bf16_f32 v138, v132, v133
    v_cvt_pk_bf16_f32 v139, v134, v135
    v_mul_f32 v96, v96, v145
    v_mul_f32 v97, v97, v145
    v_mul_f32 v98, v98, v145
    v_mul_f32 v99, v99, v145
    v_mul_f32 v100, v100, v145
    v_mul_f32 v101, v101, v145
    v_mul_f32 v102, v102, v145
    v_mul_f32 v103, v103, v145
    v_mul_f32 v104, v104, v145
    v_mul_f32 v105, v105, v145
    v_mul_f32 v106, v106, v145
    v_mul_f32 v107, v107, v145
    v_mul_f32 v108, v108, v145
    v_mul_f32 v109, v109, v145
    v_mul_f32 v110, v110, v145
    v_mul_f32 v111, v111, v145
    v_mul_f32 v112, v112, v145
    v_mul_f32 v113, v113, v145
    v_mul_f32 v114, v114, v145
    v_mul_f32 v115, v115, v145
    v_mul_f32 v116, v116, v145
    v_mul_f32 v117, v117, v145
    v_mul_f32 v118, v118, v145
    v_mul_f32 v119, v119, v145
    v_mul_f32 v120, v120, v145
    v_mul_f32 v121, v121, v145
    v_mul_f32 v122, v122, v145
    v_mul_f32 v123, v123, v145
    v_mul_f32 v124, v124, v145
    v_mul_f32 v125, v125, v145
    v_mul_f32 v126, v126, v145
    v_mul_f32 v127, v127, v145
    s_nop 1
    v_mfma_f32_16x16x32_bf16 v[96:99], v[216:219], v[136:139], v[96:99]
    v_mfma_f32_16x16x32_bf16 v[100:103], v[220:223], v[136:139], v[100:103]
    v_mfma_f32_16x16x32_bf16 v[104:107], v[224:227], v[136:139], v[104:107]
    v_mfma_f32_16x16x32_bf16 v[108:111], v[228:231], v[136:139], v[108:111]
    v_mfma_f32_16x16x32_bf16 v[112:115], v[232:235], v[136:139], v[112:115]
    v_mfma_f32_16x16x32_bf16 v[116:119], v[236:239], v[136:139], v[116:119]
    v_mfma_f32_16x16x32_bf16 v[120:123], v[240:243], v[136:139], v[120:123]
    v_mfma_f32_16x16x32_bf16 v[124:127], v[244:247], v[136:139], v[124:127]
    s_nop 7
    s_nop 1
    s_branch C_loop
C_done:
    v_mov_b32 v145, v141
    s_nop 1
    v_permlane16_swap_b32 v141, v145
    s_nop 0
    v_add_f32 v141, v141, v145
    v_mov_b32 v145, v141
    s_nop 1
    v_permlane32_swap_b32 v141, v145
    s_nop 0
    v_add_f32 v141, v141, v145
    s_mul_i32 s33, s28, 2304
    s_add_u32 s33, s33, 135168
    v_lshlrev_b32 v144, 9, v2
    v_lshl_add_u32 v144, v3, 4, v144
    v_add_u32 v144, s33, v144
    v_lshlrev_b32 v145, 3, v2
    v_add_u32 v145, s33, v145
    v_cmp_gt_u32 vcc, 4, v2
    s_and_saveexec_b64 s[64:65], vcc
    ds_write_b128 v144, v[96:99] offset:0
    ds_write_b128 v144, v[100:103] offset:64
    ds_write_b128 v144, v[104:107] offset:128
    ds_write_b128 v144, v[108:111] offset:192
    ds_write_b128 v144, v[112:115] offset:256
    ds_write_b128 v144, v[116:119] offset:320
    ds_write_b128 v144, v[120:123] offset:384
    ds_write_b128 v144, v[124:127] offset:448
    ds_write_b64 v145, v[140:141] offset:2048
    s_mov_b64 exec, s[64:65]
    s_waitcnt lgkmcnt(0)
    s_barrier
    s_lshl_b32 s33, s28, 9
    s_add_u32 s33, s33, 135168
    v_lshlrev_b32 v144, 3, v1
    v_add_u32 v146, s33, v144
    s_lshl_b32 s33, s28, 3
    s_add_u32 s33, s33, 137216
    v_mov_b32 v145, s33
    ds_read_b64 v[32:33], v146 offset:0
    ds_read_b64 v[40:41], v145 offset:0
    ds_read_b64 v[34:35], v146 offset:2304
    ds_read_b64 v[42:43], v145 offset:2304
    ds_read_b64 v[36:37], v146 offset:4608
    ds_read_b64 v[44:45], v145 offset:4608
    ds_read_b64 v[38:39], v146 offset:6912
    ds_read_b64 v[46:47], v145 offset:6912
    s_waitcnt lgkmcnt(0)
    v_max3_f32 v48, v40, v42, v44
    v_max_f32 v48, v48, v46
    v_sub_f32 v50, v40, v48
    v_mul_f32 v50, s60, v50
    v_exp_f32 v50, v50
    v_sub_f32 v51, v42, v48
    v_mul_f32 v51, s60, v51
    v_exp_f32 v51, v51
    v_sub_f32 v52, v44, v48
    v_mul_f32 v52, s60, v52
    v_exp_f32 v52, v52
    v_sub_f32 v53, v46, v48
    v_mul_f32 v53, s60, v53
    v_exp_f32 v53, v53
    s_nop 0
    v_mul_f32 v49, v41, v50
    v_mul_f32 v54, v32, v50
    v_mul_f32 v55, v33, v50
    v_fmac_f32 v49, v43, v51
    v_fmac_f32 v54, v34, v51
    v_fmac_f32 v55, v35, v51
    v_fmac_f32 v49, v45, v52
    v_fmac_f32 v54, v36, v52
    v_fmac_f32 v55, v37, v52
    v_fmac_f32 v49, v47, v53
    v_fmac_f32 v54, v38, v53
    v_fmac_f32 v55, v39, v53
    s_lshl_b32 s33, s28, 9
    s_add_u32 s33, s33, s34
    buffer_store_dwordx2 v[54:55], v144, s[36:39], s33 offen offset:0 sc1
    s_lshl_b32 s33, s28, 3
    s_add_u32 s33, s33, s34
    v_cmp_eq_u32 vcc, 0, v1
    s_and_saveexec_b64 s[64:65], vcc
    buffer_store_dwordx2 v[48:49], v144, s[36:39], s33 offen offset:2048 sc1
    s_mov_b64 exec, s[64:65]
    s_and_b32 s62, s2, 3
    s_lshr_b32 s63, s28, 1
    s_lshl_b32 s63, s63, 3
    s_bfe_u32 s33, s2, 0x30002
    s_add_u32 s63, s63, s33
    s_lshl_b32 s63, s63, 17
    s_lshl_b32 s69, s62, 9
    s_add_u32 s69, s69, s63
    s_lshl_b32 s70, s62, 3
    s_add_u32 s70, s70, s63
    v_and_b32 v4, 127, v0
    v_lshlrev_b32 v4, 2, v4
    v_lshlrev_b32 v5, 13, v2
    v_add_u32 v201, 8192, v4
    v_add_u32 v202, 16384, v4
    v_add_u32 v203, 24576, v4
    v_add_u32 v204, 32768, v4
    v_add_u32 v205, 40960, v4
    v_add_u32 v206, 49152, v4
    v_add_u32 v207, 57344, v4
    v_add_u32 v208, 65536, v4
    v_add_u32 v209, 73728, v4
    v_add_u32 v210, 81920, v4
    v_add_u32 v211, 90112, v4
    v_add_u32 v212, 98304, v4
    v_add_u32 v213, 106496, v4
    v_add_u32 v214, 114688, v4
    v_add_u32 v215, 122880, v4
    s_mov_b32 s66, 0
PL_23:
    buffer_load_dwordx2 v[6:7], v5, s[36:39], s70 offen offset:2048 sc1
    buffer_load_dword v8, v4, s[36:39], s69 offen offset:0 sc1
    buffer_load_dword v9, v201, s[36:39], s69 offen offset:0 sc1
    buffer_load_dword v10, v202, s[36:39], s69 offen offset:0 sc1
    buffer_load_dword v11, v203, s[36:39], s69 offen offset:0 sc1
    buffer_load_dword v12, v204, s[36:39], s69 offen offset:0 sc1
    buffer_load_dword v13, v205, s[36:39], s69 offen offset:0 sc1
    buffer_load_dword v14, v206, s[36:39], s69 offen offset:0 sc1
    buffer_load_dword v15, v207, s[36:39], s69 offen offset:0 sc1
    buffer_load_dword v16, v208, s[36:39], s69 offen offset:0 sc1
    buffer_load_dword v17, v209, s[36:39], s69 offen offset:0 sc1
    buffer_load_dword v18, v210, s[36:39], s69 offen offset:0 sc1
    buffer_load_dword v19, v211, s[36:39], s69 offen offset:0 sc1
    buffer_load_dword v20, v212, s[36:39], s69 offen offset:0 sc1
    buffer_load_dword v21, v213, s[36:39], s69 offen offset:0 sc1
    buffer_load_dword v22, v214, s[36:39], s69 offen offset:0 sc1
    buffer_load_dword v23, v215, s[36:39], s69 offen offset:0 sc1
    s_waitcnt vmcnt(0)
    v_mov_b32 v28, v6
    v_max3_u32 v28, v28, v7, v8
    v_max3_u32 v28, v28, v9, v10
    v_max3_u32 v28, v28, v11, v12
    v_max3_u32 v28, v28, v13, v14
    v_max3_u32 v28, v28, v15, v16
    v_max3_u32 v28, v28, v17, v18
    v_max3_u32 v28, v28, v19, v20
    v_max3_u32 v28, v28, v21, v22
    v_max_u32 v28, v28, v23
    v_cmp_eq_u32 vcc, -1, v28
    s_add_u32 s66, s66, 1
    s_cmp_eq_u64 vcc, 0
    s_cbranch_scc1 PG_24
    s_cmp_lt_u32 s66, 400000
    s_cbranch_scc1 PL_23
PG_24:
    v_mov_b32 v28, v6
    s_nop 1
    v_max_f32_dpp v28, v28, v28 quad_perm:[1,0,3,2] row_mask:0xf bank_mask:0xf
    s_nop 1
    v_max_f32_dpp v28, v28, v28 quad_perm:[2,3,0,1] row_mask:0xf bank_mask:0xf
    s_nop 1
    v_max_f32_dpp v28, v28, v28 row_ror:4 row_mask:0xf bank_mask:0xf
    s_nop 1
    v_max_f32_dpp v28, v28, v28 row_ror:8 row_mask:0xf bank_mask:0xf
    v_sub_f32 v29, v6, v28
    v_mul_f32 v29, s60, v29
    v_exp_f32 v29, v29
    s_nop 0
    v_mul_f32 v30, v29, v7
    s_nop 1
    v_add_f32_dpp v30, v30, v30 quad_perm:[1,0,3,2] row_mask:0xf bank_mask:0xf
    s_nop 1
    v_add_f32_dpp v30, v30, v30 quad_perm:[2,3,0,1] row_mask:0xf bank_mask:0xf
    s_nop 1
    v_add_f32_dpp v30, v30, v30 row_ror:4 row_mask:0xf bank_mask:0xf
    s_nop 1
    v_add_f32_dpp v30, v30, v30 row_ror:8 row_mask:0xf bank_mask:0xf
    v_rcp_f32 v31, v30
    s_nop 1
    v_readlane_b32 s66, v29, 0
    v_readlane_b32 s67, v29, 1
    v_readlane_b32 s68, v29, 2
    v_readlane_b32 s69, v29, 3
    v_readlane_b32 s70, v29, 4
    v_readlane_b32 s71, v29, 5
    v_readlane_b32 s72, v29, 6
    v_readlane_b32 s73, v29, 7
    v_readlane_b32 s74, v29, 8
    v_readlane_b32 s75, v29, 9
    v_readlane_b32 s76, v29, 10
    v_readlane_b32 s77, v29, 11
    v_readlane_b32 s78, v29, 12
    v_readlane_b32 s79, v29, 13
    v_readlane_b32 s80, v29, 14
    v_readlane_b32 s81, v29, 15
    s_nop 1
    v_mul_f32 v27, s66, v8
    v_fmac_f32 v27, s67, v9
    v_fmac_f32 v27, s68, v10
    v_fmac_f32 v27, s69, v11
    v_fmac_f32 v27, s70, v12
    v_fmac_f32 v27, s71, v13
    v_fmac_f32 v27, s72, v14
    v_fmac_f32 v27, s73, v15
    v_fmac_f32 v27, s74, v16
    v_fmac_f32 v27, s75, v17
    v_fmac_f32 v27, s76, v18
    v_fmac_f32 v27, s77, v19
    v_fmac_f32 v27, s78, v20
    v_fmac_f32 v27, s79, v21
    v_fmac_f32 v27, s80, v22
    v_fmac_f32 v27, s81, v23
    v_mul_f32 v8, v27, v31
    v_fma_f32 v9, -v8, v30, v27
    v_fmac_f32 v8, v9, v31
    v_cvt_pk_bf16_f32 v8, v8, v8
    v_and_b32 v8, 0xffff, v8
    v_lshlrev_b32 v9, 2, v0
    v_add_u32 v9, 144384, v9
    ds_write_b32 v9, v8
    s_waitcnt lgkmcnt(0)
    s_barrier
    s_barrier
    s_and_b32 s33, s2, 31
    s_cmp_lg_u32 s33, 28
    s_cbranch_scc1 DONE
    s_cmp_ge_u32 s28, 2
    s_cbranch_scc1 DONE
    v_lshlrev_b32 v4, 2, v0
    s_lshl_b32 s33, s35, 18
    v_add_u32 v201, 8192, v4
    v_add_u32 v202, 16384, v4
    v_add_u32 v203, 24576, v4
    v_add_u32 v204, 32768, v4
    v_add_u32 v205, 40960, v4
    v_add_u32 v206, 49152, v4
    v_add_u32 v207, 57344, v4
    v_add_u32 v208, 65536, v4
    v_add_u32 v209, 73728, v4
    v_add_u32 v210, 81920, v4
    v_add_u32 v211, 90112, v4
    v_add_u32 v212, 98304, v4
    v_add_u32 v213, 106496, v4
    v_add_u32 v214, 114688, v4
    v_add_u32 v215, 122880, v4
    v_add_u32 v216, 131072, v4
    v_add_u32 v217, 139264, v4
    v_add_u32 v218, 147456, v4
    v_add_u32 v219, 155648, v4
    v_add_u32 v220, 163840, v4
    v_add_u32 v221, 172032, v4
    v_add_u32 v222, 180224, v4
    v_add_u32 v223, 188416, v4
    v_add_u32 v224, 196608, v4
    v_add_u32 v225, 204800, v4
    v_add_u32 v226, 212992, v4
    v_add_u32 v227, 221184, v4
    v_add_u32 v228, 229376, v4
    v_add_u32 v229, 237568, v4
    v_add_u32 v230, 245760, v4
    v_add_u32 v231, 253952, v4
    s_lshl_b32 s62, s35, 7
    v_lshlrev_b32 v5, 1, v1
    s_lshl_b32 s63, s28, 10
    s_add_u32 s62, s62, s63
    buffer_load_ushort v6, v5, s[44:47], s62 offen
    v_add_u32 v7, 147456, v4
    ds_read_b32 v100, v7
    s_mov_b32 s66, 0
PL_25:
    buffer_load_dword v64, v4, s[36:39], s33 offen offset:2560 sc1
    buffer_load_dword v65, v201, s[36:39], s33 offen offset:2560 sc1
    buffer_load_dword v66, v202, s[36:39], s33 offen offset:2560 sc1
    buffer_load_dword v67, v203, s[36:39], s33 offen offset:2560 sc1
    buffer_load_dword v68, v204, s[36:39], s33 offen offset:2560 sc1
    buffer_load_dword v69, v205, s[36:39], s33 offen offset:2560 sc1
    buffer_load_dword v70, v206, s[36:39], s33 offen offset:2560 sc1
    buffer_load_dword v71, v207, s[36:39], s33 offen offset:2560 sc1
    buffer_load_dword v72, v208, s[36:39], s33 offen offset:2560 sc1
    buffer_load_dword v73, v209, s[36:39], s33 offen offset:2560 sc1
    buffer_load_dword v74, v210, s[36:39], s33 offen offset:2560 sc1
    buffer_load_dword v75, v211, s[36:39], s33 offen offset:2560 sc1
    buffer_load_dword v76, v212, s[36:39], s33 offen offset:2560 sc1
    buffer_load_dword v77, v213, s[36:39], s33 offen offset:2560 sc1
    buffer_load_dword v78, v214, s[36:39], s33 offen offset:2560 sc1
    buffer_load_dword v79, v215, s[36:39], s33 offen offset:2560 sc1
    buffer_load_dword v80, v216, s[36:39], s33 offen offset:2560 sc1
    buffer_load_dword v81, v217, s[36:39], s33 offen offset:2560 sc1
    buffer_load_dword v82, v218, s[36:39], s33 offen offset:2560 sc1
    buffer_load_dword v83, v219, s[36:39], s33 offen offset:2560 sc1
    buffer_load_dword v84, v220, s[36:39], s33 offen offset:2560 sc1
    buffer_load_dword v85, v221, s[36:39], s33 offen offset:2560 sc1
    buffer_load_dword v86, v222, s[36:39], s33 offen offset:2560 sc1
    buffer_load_dword v87, v223, s[36:39], s33 offen offset:2560 sc1
    buffer_load_dword v88, v224, s[36:39], s33 offen offset:2560 sc1
    buffer_load_dword v89, v225, s[36:39], s33 offen offset:2560 sc1
    buffer_load_dword v90, v226, s[36:39], s33 offen offset:2560 sc1
    buffer_load_dword v91, v227, s[36:39], s33 offen offset:2560 sc1
    buffer_load_dword v92, v228, s[36:39], s33 offen offset:2560 sc1
    buffer_load_dword v93, v229, s[36:39], s33 offen offset:2560 sc1
    buffer_load_dword v94, v230, s[36:39], s33 offen offset:2560 sc1
    buffer_load_dword v95, v231, s[36:39], s33 offen offset:2560 sc1
    s_waitcnt vmcnt(0)
    v_mov_b32 v28, v64
    v_max3_u32 v28, v28, v65, v66
    v_max3_u32 v28, v28, v67, v68
    v_max3_u32 v28, v28, v69, v70
    v_max3_u32 v28, v28, v71, v72
    v_max3_u32 v28, v28, v73, v74
    v_max3_u32 v28, v28, v75, v76
    v_max3_u32 v28, v28, v77, v78
    v_max3_u32 v28, v28, v79, v80
    v_max3_u32 v28, v28, v81, v82
    v_max3_u32 v28, v28, v83, v84
    v_max3_u32 v28, v28, v85, v86
    v_max3_u32 v28, v28, v87, v88
    v_max3_u32 v28, v28, v89, v90
    v_max3_u32 v28, v28, v91, v92
    v_max3_u32 v28, v28, v93, v94
    v_max_u32 v28, v28, v95
    v_cmp_eq_u32 vcc, -1, v28
    s_add_u32 s66, s66, 1
    s_cmp_eq_u64 vcc, 0
    s_cbranch_scc1 PG_26
    s_cmp_lt_u32 s66, 400000
    s_cbranch_scc1 PL_25
PG_26:
    v_add_f32 v64, v64, v80
    v_add_f32 v65, v65, v81
    v_add_f32 v66, v66, v82
    v_add_f32 v67, v67, v83
    v_add_f32 v68, v68, v84
    v_add_f32 v69, v69, v85
    v_add_f32 v70, v70, v86
    v_add_f32 v71, v71, v87
    v_add_f32 v72, v72, v88
    v_add_f32 v73, v73, v89
    v_add_f32 v74, v74, v90
    v_add_f32 v75, v75, v91
    v_add_f32 v76, v76, v92
    v_add_f32 v77, v77, v93
    v_add_f32 v78, v78, v94
    v_add_f32 v79, v79, v95
    v_add_f32 v64, v64, v72
    v_add_f32 v65, v65, v73
    v_add_f32 v66, v66, v74
    v_add_f32 v67, v67, v75
    v_add_f32 v68, v68, v76
    v_add_f32 v69, v69, v77
    v_add_f32 v70, v70, v78
    v_add_f32 v71, v71, v79
    v_add_f32 v64, v64, v68
    v_add_f32 v65, v65, v69
    v_add_f32 v66, v66, v70
    v_add_f32 v67, v67, v71
    v_add_f32 v64, v64, v66
    v_add_f32 v65, v65, v67
    v_add_f32 v64, v64, v65
    s_waitcnt lgkmcnt(0)
    v_cvt_pk_bf16_f32 v64, v64, v64
    v_lshlrev_b32 v64, 16, v64
    v_mul_f32 v67, v64, v100
    v_cvt_pk_bf16_f32 v67, v67, v67
    v_lshlrev_b32 v67, 16, v67
    v_lshlrev_b32 v6, 16, v6
    v_add_f32 v67, v6, v67
    v_cvt_pk_bf16_f32 v67, v67, v67
    s_mov_b32 s48, s22
    s_mov_b32 s49, s23
    s_mov_b32 s50, 2048
    s_mov_b32 s51, 0x00020000
    buffer_store_short v67, v5, s[48:51], s62 offen
    s_branch DONE
ROLE_HI:
    s_mov_b32 s48, s12
    s_mov_b32 s49, s13
    s_mov_b32 s50, 4194304
    s_mov_b32 s51, 0x00020000
    v_subrev_u32 v4, 256, v0
    v_lshrrev_b32 v5, 3, v4
    v_and_b32 v6, 7, v4
    v_lshlrev_b32 v7, 12, v5
    v_lshl_add_u32 v7, v6, 4, v7
    s_and_b32 s62, s2, 31
    s_lshl_b32 s62, s62, 17
    s_lshl_b32 s63, s35, 7
    s_add_u32 s62, s62, s63
    v_mov_b32 v24, 131072
    s_cmp_lg_u32 s28, 4
    s_cbranch_scc1 ROLE_H
    s_setprio 3
    s_lshl_b32 s64, s29, 23
    s_lshl_b32 s75, s30, 19
    s_add_u32 s52, s6, s64
    s_addc_u32 s53, s7, 0
    s_mov_b32 s54, 0x800000
    s_mov_b32 s55, 0x00020000
    s_add_u32 s56, s8, s64
    s_addc_u32 s57, s9, 0
    s_mov_b32 s58, 0x800000
    s_mov_b32 s59, 0x00020000
    v_lshlrev_b32 v8, 1, v3
    v_xor_b32 v8, v2, v8
    v_lshlrev_b32 v8, 4, v8
    v_lshl_add_u32 v8, v3, 8, v8
    v_xor_b32 v9, 0x80, v8
    s_mul_i32 s66, s2, 1
    s_and_b32 s66, s66, 63
    s_lshl_b32 s76, s66, 13
    s_add_u32 s66, s76, s75
    s_mov_b32 s67, 0
    s_mov_b32 m0, s67
    s_nop 0
    buffer_load_dwordx4 v8, s[52:55], s66 offen offset:0 nt lds
    buffer_load_dwordx4 v9, s[52:55], s66 offen offset:1024 nt lds
    buffer_load_dwordx4 v8, s[52:55], s66 offen offset:2048 nt lds
    buffer_load_dwordx4 v9, s[52:55], s66 offen offset:3072 nt lds
    s_add_u32 m0, s67, 4096
    s_add_u32 s68, s66, 4096
    buffer_load_dwordx4 v8, s[52:55], s68 offen offset:0 nt lds
    buffer_load_dwordx4 v9, s[52:55], s68 offen offset:1024 nt lds
    buffer_load_dwordx4 v8, s[52:55], s68 offen offset:2048 nt lds
    buffer_load_dwordx4 v9, s[52:55], s68 offen offset:3072 nt lds
    s_add_u32 s67, s67, 8192
    s_and_b32 s67, s67, 0x1ffff
    s_mov_b32 m0, s67
    s_nop 0
    buffer_load_dwordx4 v8, s[56:59], s66 offen offset:0 nt lds
    buffer_load_dwordx4 v9, s[56:59], s66 offen offset:1024 nt lds
    buffer_load_dwordx4 v8, s[56:59], s66 offen offset:2048 nt lds
    buffer_load_dwordx4 v9, s[56:59], s66 offen offset:3072 nt lds
    s_add_u32 m0, s67, 4096
    s_add_u32 s68, s66, 4096
    buffer_load_dwordx4 v8, s[56:59], s68 offen offset:0 nt lds
    buffer_load_dwordx4 v9, s[56:59], s68 offen offset:1024 nt lds
    buffer_load_dwordx4 v8, s[56:59], s68 offen offset:2048 nt lds
    buffer_load_dwordx4 v9, s[56:59], s68 offen offset:3072 nt lds
    s_add_u32 s67, s67, 8192
    s_and_b32 s67, s67, 0x1ffff
    s_add_u32 s76, s76, 8192
    s_and_b32 s76, s76, 0x7ffff
    s_add_u32 s66, s76, s75
    s_mov_b32 m0, s67
    s_nop 0
    buffer_load_dwordx4 v8, s[52:55], s66 offen offset:0 nt lds
    buffer_load_dwordx4 v9, s[52:55], s66 offen offset:1024 nt lds
    buffer_load_dwordx4 v8, s[52:55], s66 offen offset:2048 nt lds
    buffer_load_dwordx4 v9, s[52:55], s66 offen offset:3072 nt lds
    s_add_u32 m0, s67, 4096
    s_add_u32 s68, s66, 4096
    buffer_load_dwordx4 v8, s[52:55], s68 offen offset:0 nt lds
    buffer_load_dwordx4 v9, s[52:55], s68 offen offset:1024 nt lds
    buffer_load_dwordx4 v8, s[52:55], s68 offen offset:2048 nt lds
    buffer_load_dwordx4 v9, s[52:55], s68 offen offset:3072 nt lds
    s_add_u32 s67, s67, 8192
    s_and_b32 s67, s67, 0x1ffff
    s_mov_b32 m0, s67
    s_nop 0
    buffer_load_dwordx4 v8, s[56:59], s66 offen offset:0 nt lds
    buffer_load_dwordx4 v9, s[56:59], s66 offen offset:1024 nt lds
    buffer_load_dwordx4 v8, s[56:59], s66 offen offset:2048 nt lds
    buffer_load_dwordx4 v9, s[56:59], s66 offen offset:3072 nt lds
    s_add_u32 m0, s67, 4096
    s_add_u32 s68, s66, 4096
    buffer_load_dwordx4 v8, s[56:59], s68 offen offset:0 nt lds
    buffer_load_dwordx4 v9, s[56:59], s68 offen offset:1024 nt lds
    buffer_load_dwordx4 v8, s[56:59], s68 offen offset:2048 nt lds
    buffer_load_dwordx4 v9, s[56:59], s68 offen offset:3072 nt lds
    s_add_u32 s67, s67, 8192
    s_and_b32 s67, s67, 0x1ffff
    s_add_u32 s76, s76, 8192
    s_and_b32 s76, s76, 0x7ffff
    s_add_u32 s66, s76, s75
    v_lshlrev_b32 v15, 2, v1
    v_add_u32 v15, 131072, v15
    v_mov_b32 v16, 0
    ds_write_b32 v15, v16
    s_waitcnt lgkmcnt(0)
    s_barrier
    s_mov_b32 s69, 0
    s_mov_b32 s70, 2
L_loop:
    s_waitcnt vmcnt(24)
    s_add_u32 s69, s69, 1
    v_mov_b32 v16, s69
    ds_write_b32 v24, v16 offset:0
    s_cmp_lt_u32 s70, 8
    s_cbranch_scc1 LF_27
    s_and_b32 s71, s70, 3
    s_lshl_b32 s71, s71, 2
    s_add_u32 s71, s71, 131088
    v_mov_b32 v17, s71
    s_lshr_b32 s72, s70, 2
    s_sub_u32 s72, s72, 1
    s_mov_b32 s82, 0
LW_28:
    ds_read_b32 v18, v17 offset:0
    s_waitcnt lgkmcnt(0)
    v_readfirstlane_b32 s73, v18
    s_add_u32 s82, s82, 1
    s_cmp_ge_u32 s73, s72
    s_cbranch_scc1 LG_29
    s_sleep 1
    s_cmp_lt_u32 s82, 0x800000
    s_cbranch_scc1 LW_28
LG_29:
LF_27:
    s_mov_b32 m0, s67
    s_nop 0
    buffer_load_dwordx4 v8, s[52:55], s66 offen offset:0 nt lds
    buffer_load_dwordx4 v9, s[52:55], s66 offen offset:1024 nt lds
    buffer_load_dwordx4 v8, s[52:55], s66 offen offset:2048 nt lds
    buffer_load_dwordx4 v9, s[52:55], s66 offen offset:3072 nt lds
    s_add_u32 m0, s67, 4096
    s_add_u32 s68, s66, 4096
    buffer_load_dwordx4 v8, s[52:55], s68 offen offset:0 nt lds
    buffer_load_dwordx4 v9, s[52:55], s68 offen offset:1024 nt lds
    buffer_load_dwordx4 v8, s[52:55], s68 offen offset:2048 nt lds
    buffer_load_dwordx4 v9, s[52:55], s68 offen offset:3072 nt lds
    s_add_u32 s67, s67, 8192
    s_and_b32 s67, s67, 0x1ffff
    s_waitcnt vmcnt(24)
    s_add_u32 s69, s69, 1
    v_mov_b32 v16, s69
    ds_write_b32 v24, v16 offset:0
    s_mov_b32 m0, s67
    s_nop 0
    buffer_load_dwordx4 v8, s[56:59], s66 offen offset:0 nt lds
    buffer_load_dwordx4 v9, s[56:59], s66 offen offset:1024 nt lds
    buffer_load_dwordx4 v8, s[56:59], s66 offen offset:2048 nt lds
    buffer_load_dwordx4 v9, s[56:59], s66 offen offset:3072 nt lds
    s_add_u32 m0, s67, 4096
    s_add_u32 s68, s66, 4096
    buffer_load_dwordx4 v8, s[56:59], s68 offen offset:0 nt lds
    buffer_load_dwordx4 v9, s[56:59], s68 offen offset:1024 nt lds
    buffer_load_dwordx4 v8, s[56:59], s68 offen offset:2048 nt lds
    buffer_load_dwordx4 v9, s[56:59], s68 offen offset:3072 nt lds
    s_add_u32 s67, s67, 8192
    s_and_b32 s67, s67, 0x1ffff
    s_add_u32 s76, s76, 8192
    s_and_b32 s76, s76, 0x7ffff
    s_add_u32 s66, s76, s75
    s_add_u32 s70, s70, 1
    s_cmp_lt_u32 s70, 54
    s_cbranch_scc1 L_loop
    s_sub_u32 s77, s70, 53
    s_mov_b32 s82, 0
LW_30:
    ds_read_b32 v18, v24 offset:52
    s_waitcnt lgkmcnt(0)
    v_readfirstlane_b32 s73, v18
    s_add_u32 s82, s82, 1
    s_cmp_ge_u32 s73, s77
    s_cbranch_scc1 LG_31
    s_sleep 1
    s_cmp_lt_u32 s82, 0x800000
    s_cbranch_scc1 LW_30
LG_31:
    s_lshl_b32 s71, s77, 2
    s_add_u32 s71, s71, 131132
    v_mov_b32 v17, s71
    ds_read_b32 v18, v17
    v_mov_b32 v16, s77
    ds_write_b32 v24, v16 offset:56
    s_waitcnt lgkmcnt(0)
    v_readfirstlane_b32 s71, v18
    s_nop 0
    s_cmp_ge_u32 s71, 160
    s_cbranch_scc1 L_done
    s_and_b32 s72, s71, 15
    s_lshr_b32 s71, s71, 4
    s_lshl_b32 s73, s29, 4
    s_lshl_b32 s74, s72, 0
    s_add_u32 s73, s73, s74
    s_mul_i32 s73, s73, 1
    s_add_u32 s73, s73, s71
    s_add_u32 s73, s73, 54
    s_and_b32 s73, s73, 63
    s_lshl_b32 s73, s73, 13
    s_lshl_b32 s72, s72, 19
    s_add_u32 s66, s72, s73
    s_branch L_loop
L_done:
    s_lshl_b32 s71, s70, 1
    v_mov_b32 v16, s71
    ds_write_b32 v24, v16 offset:4
    buffer_load_dwordx4 v[32:35], v7, s[48:51], s62 offen offset:0 nt
    buffer_load_dwordx4 v[36:39], v7, s[48:51], s62 offen offset:1024 nt
    buffer_load_dwordx4 v[40:43], v7, s[48:51], s62 offen offset:2048 nt
    buffer_load_dwordx4 v[44:47], v7, s[48:51], s62 offen offset:3072 nt
    s_waitcnt vmcnt(28)
    s_add_u32 s69, s69, 1
    v_mov_b32 v16, s69
    ds_write_b32 v24, v16 offset:0
    s_waitcnt vmcnt(20)
    s_add_u32 s69, s69, 1
    v_mov_b32 v16, s69
    ds_write_b32 v24, v16 offset:0
    s_waitcnt vmcnt(12)
    s_add_u32 s69, s69, 1
    v_mov_b32 v16, s69
    ds_write_b32 v24, v16 offset:0
    s_waitcnt vmcnt(4)
    s_add_u32 s69, s69, 1
    v_mov_b32 v16, s69
    ds_write_b32 v24, v16 offset:0
    s_waitcnt lgkmcnt(0)
    s_branch HI_TAIL
ROLE_H:
    s_cmp_lg_u32 s28, 5
    s_cbranch_scc1 ROLE_H67
    v_lshlrev_b32 v10, 4, v1
    s_lshl_b32 s71, s2, 10
    s_add_u32 s71, s71, 2097152
    v_mov_b32 v16, -1
    v_mov_b32 v17, -1
    v_mov_b32 v18, -1
    v_mov_b32 v19, -1
    buffer_store_dwordx4 v[16:19], v10, s[36:39], s71 offen sc1
    s_barrier
    v_and_b32 v13, 3, v1
    v_lshlrev_b32 v13, 4, v13
    v_lshrrev_b32 v11, 2, v1
    v_lshlrev_b32 v11, 10, v11
    v_add_u32 v11, v11, v13
    s_lshl_b32 s72, s29, 14
    s_lshl_b32 s73, s30, 6
    s_add_u32 s72, s72, s73
    s_add_u32 s72, s72, 2097152
    v_mov_b32 v15, 1
    s_mov_b32 s82, 0
LW_32:
    ds_read_b32 v16, v24 offset:32
    s_waitcnt lgkmcnt(0)
    v_readfirstlane_b32 s33, v16
    s_add_u32 s82, s82, 1
    s_cmp_ge_u32 s33, 4
    s_cbranch_scc1 LG_33
    s_sleep 0
    s_cmp_lt_u32 s82, 0x800000
    s_cbranch_scc1 LW_32
LG_33:
    v_lshlrev_b32 v12, 3, v2
    v_add_u32 v12, 133376, v12
    ds_read_b64 v[16:17], v12 offset:0
    ds_read_b64 v[18:19], v12 offset:128
    ds_read_b64 v[20:21], v12 offset:256
    ds_read_b64 v[22:23], v12 offset:384
    s_waitcnt lgkmcnt(0)
    v_add_f32 v16, v16, v18
    v_add_f32 v17, v17, v19
    v_add_f32 v20, v20, v22
    v_add_f32 v21, v21, v23
    v_add_f32 v16, v16, v20
    v_add_f32 v17, v17, v21
    v_cvt_pk_bf16_f32 v16, v16, v17
    v_lshlrev_b32 v12, 2, v2
    v_add_u32 v12, 134144, v12
    ds_write_b32 v12, v16
    v_add_u32 v12, 134144, v13
    s_waitcnt lgkmcnt(0)
    ds_read_b128 v[20:23], v12
    s_waitcnt vmcnt(0) lgkmcnt(0)
    buffer_store_dwordx4 v[20:23], v11, s[36:39], s72 offen sc1
    s_mov_b32 s66, 0
PL_34:
    buffer_load_dwordx4 v[16:19], v10, s[36:39], s71 offen sc1
    s_waitcnt vmcnt(0)
    v_mov_b32 v26, v16
    v_max3_u32 v26, v26, v17, v18
    v_max_u32 v26, v26, v19
    v_cmp_eq_u32 vcc, -1, v26
    s_add_u32 s66, s66, 1
    s_cmp_eq_u64 vcc, 0
    s_cbranch_scc1 PG_35
    s_cmp_lt_u32 s66, 400000
    s_cbranch_scc1 PL_34
PG_35:
    v_add_u32 v13, 134144, v10
    ds_write_b128 v13, v[16:19]
    s_waitcnt lgkmcnt(0)
    ds_write_b32 v24, v15 offset:36
    buffer_store_dwordx4 v[20:23], v11, s[36:39], s72 offen sc1
    s_waitcnt lgkmcnt(0)
    s_mov_b32 s40, s24
    s_mov_b32 s41, s25
    s_mov_b32 s42, 256
    s_mov_b32 s43, 0x00020000
    v_mov_b32 v8, -1
    v_mov_b32 v9, -1
    v_mov_b32 v10, -1
    v_mov_b32 v11, -1
    v_lshlrev_b32 v12, 4, v1
    s_add_u32 s33, s34, 4096
    buffer_store_dwordx4 v[8:11], v12, s[36:39], s34 offen offset:0 sc1
    buffer_store_dwordx4 v[8:11], v12, s[36:39], s34 offen offset:1024 sc1
    buffer_store_dwordx4 v[8:11], v12, s[36:39], s34 offen offset:2048 sc1
    buffer_store_dwordx4 v[8:11], v12, s[36:39], s34 offen offset:3072 sc1
    buffer_store_dwordx4 v[8:11], v12, s[36:39], s33 offen sc1
    s_lshl_b32 s78, s29, 8
    s_add_u32 s78, s78, 2359296
    v_mov_b32 v27, 0
    s_cmp_lg_u32 s30, 0
    s_cbranch_scc1 H5_notlead
    buffer_store_dword v27, v27, s[36:39], s78 offen sc1
H5_notlead:
    s_and_b32 s83, s29, 3
    s_lshl_b32 s83, s83, 6
    s_and_b32 s33, s29, 12
    s_add_u32 s83, s83, s33
    v_mov_b32 v13, s83
    v_mov_b32 v14, 1
    s_waitcnt vmcnt(0)
    v_cmp_eq_u32 vcc, 0, v1
    s_and_saveexec_b64 s[64:65], vcc
    buffer_atomic_add v14, v13, s[40:43], 0 offen
    s_mov_b64 exec, s[64:65]
    buffer_load_dwordx4 v[32:35], v7, s[48:51], s62 offen offset:0 nt
    buffer_load_dwordx4 v[36:39], v7, s[48:51], s62 offen offset:1024 nt
    buffer_load_dwordx4 v[40:43], v7, s[48:51], s62 offen offset:2048 nt
    buffer_load_dwordx4 v[44:47], v7, s[48:51], s62 offen offset:3072 nt
    s_mov_b32 s82, 0
LW_36:
    ds_read_b32 v25, v24 offset:0
    s_waitcnt lgkmcnt(0)
    v_readfirstlane_b32 s33, v25
    s_add_u32 s82, s82, 1
    s_cmp_ge_u32 s33, 32
    s_cbranch_scc1 LG_37
    s_sleep 8
    s_cmp_lt_u32 s82, 0x800000
    s_cbranch_scc1 LW_36
LG_37:
    v_and_b32 v26, 3, v1
    v_lshlrev_b32 v26, 6, v26
    v_and_b32 v25, 12, v1
    v_add_u32 v26, v26, v25
    s_mov_b32 s66, 0
WC_38:
    buffer_load_dword v25, v26, s[40:43], 0 offen sc1
    s_waitcnt vmcnt(0)
    v_cmp_gt_u32 vcc, 16, v25
    s_add_u32 s66, s66, 1
    s_cmp_eq_u64 vcc, 0
    s_cbranch_scc1 WG_39
    s_sleep 32
    s_cmp_lt_u32 s66, 400000
    s_cbranch_scc1 WC_38
WG_39:
    v_mov_b32 v25, 1
    ds_write_b32 v24, v25 offset:40
    s_waitcnt lgkmcnt(0)
    s_mov_b32 s82, 0
LW_40:
    ds_read_b32 v25, v24 offset:0
    s_waitcnt lgkmcnt(0)
    v_readfirstlane_b32 s33, v25
    s_add_u32 s82, s82, 1
    s_cmp_ge_u32 s33, 92
    s_cbranch_scc1 LG_41
    s_sleep 8
    s_cmp_lt_u32 s82, 0x800000
    s_cbranch_scc1 LW_40
LG_41:
    s_mov_b32 s79, 0
    s_mov_b32 s80, 0
    s_mov_b32 s77, 0
    s_mov_b64 s[64:65], exec
    s_mov_b64 exec, 1
A_loop:
    ds_read_b32 v25, v24 offset:56
    s_waitcnt lgkmcnt(0)
    v_readfirstlane_b32 s81, v25
    s_nop 0
    s_add_u32 s33, s81, 2
    s_min_u32 s33, s33, 46
    s_cmp_ge_u32 s79, s33
    s_cbranch_scc1 A_pub
    s_and_b32 s33, s79, 3
    s_lshl_b64 exec, 1, s33
    v_mov_b32 v29, 1
    buffer_atomic_add v29, v27, s[36:39], s78 offen sc0
    s_mov_b64 exec, 1
    s_add_u32 s79, s79, 1
    s_branch A_loop
A_pub:
    s_cmp_ge_u32 s80, s79
    s_cbranch_scc1 A_idle
    s_sub_u32 s33, s79, s80
    s_cmp_ge_u32 s33, 3
    s_cbranch_scc1 A_w2
    s_cmp_ge_u32 s33, 2
    s_cbranch_scc1 A_w1
    s_waitcnt vmcnt(0)
A_w1:
    s_waitcnt vmcnt(1)
A_w2:
    s_waitcnt vmcnt(2)
    s_and_b32 s33, s80, 3
    v_readlane_b32 s76, v29, s33
    s_lshl_b32 s33, s80, 2
    s_add_u32 s33, s33, 131136
    v_mov_b32 v30, s33
    v_mov_b32 v31, s76
    ds_write_b32 v30, v31
    s_add_u32 s80, s80, 1
    v_mov_b32 v31, s80
    s_waitcnt lgkmcnt(0)
    ds_write_b32 v24, v31 offset:52
    s_cmp_ge_u32 s76, 160
    s_cbranch_scc1 A_done
    s_branch A_loop
A_idle:
    s_cmp_ge_u32 s80, 46
    s_cbranch_scc1 A_full
    s_sleep 1
    s_add_u32 s77, s77, 1
    s_cmp_lt_u32 s77, 0x800000
    s_cbranch_scc1 A_loop
A_full:
    s_lshl_b32 s33, s80, 2
    s_add_u32 s33, s33, 131136
    v_mov_b32 v30, s33
    v_mov_b32 v31, -1
    ds_write_b32 v30, v31
    s_add_u32 s80, s80, 1
    v_mov_b32 v31, s80
    s_waitcnt lgkmcnt(0)
    ds_write_b32 v24, v31 offset:52
A_done:
    s_waitcnt lgkmcnt(0)
    s_mov_b64 exec, s[64:65]
    s_branch HI_TAIL
ROLE_H67:
    s_barrier
    s_mov_b32 s82, 0
LW_42:
    ds_read_b32 v25, v24 offset:36
    s_waitcnt lgkmcnt(0)
    v_readfirstlane_b32 s33, v25
    s_add_u32 s82, s82, 1
    s_cmp_ge_u32 s33, 1
    s_cbranch_scc1 LG_43
    s_sleep 4
    s_cmp_lt_u32 s82, 0x800000
    s_cbranch_scc1 LW_42
LG_43:
    buffer_load_dwordx4 v[32:35], v7, s[48:51], s62 offen offset:0 nt
    buffer_load_dwordx4 v[36:39], v7, s[48:51], s62 offen offset:1024 nt
    buffer_load_dwordx4 v[40:43], v7, s[48:51], s62 offen offset:2048 nt
    buffer_load_dwordx4 v[44:47], v7, s[48:51], s62 offen offset:3072 nt
    v_lshrrev_b32 v8, 3, v1
    v_and_b32 v9, 7, v1
    s_sub_u32 s74, s28, 6
    s_cmp_ge_u32 s2, 224
    s_cbranch_scc1 H67_noffn1
    s_cmp_eq_u32 s28, 6
    s_cselect_b32 s52, s16, s18
    s_cselect_b32 s53, s17, s19
    s_mov_b32 s54, 1835008
    s_mov_b32 s55, 0x00020000
    v_lshlrev_b32 v12, 4, v1
    buffer_load_dwordx4 v[16:19], v12, s[44:47], 0 offen
    buffer_load_dwordx4 v[20:23], v12, s[44:47], 0 offen offset:1024
    v_mul_u32_u24 v10, 28672, v8
    v_lshl_add_u32 v10, v9, 4, v10
    s_lshr_b32 s64, s2, 3
    s_lshl_b32 s64, s64, 7
    s_and_b32 s81, s2, 7
    s_mul_i32 s65, s81, 229376
    s_add_u32 s66, s64, s65
    buffer_load_dwordx4 v[64:67], v10, s[52:55], s66 offen nt
    s_add_u32 s66, s66, 3584
    buffer_load_dwordx4 v[68:71], v10, s[52:55], s66 offen nt
    s_add_u32 s66, s66, 3584
    buffer_load_dwordx4 v[72:75], v10, s[52:55], s66 offen nt
    s_add_u32 s66, s66, 3584
    buffer_load_dwordx4 v[76:79], v10, s[52:55], s66 offen nt
    s_add_u32 s66, s66, 3584
    buffer_load_dwordx4 v[80:83], v10, s[52:55], s66 offen nt
    s_add_u32 s66, s66, 3584
    buffer_load_dwordx4 v[84:87], v10, s[52:55], s66 offen nt
    s_add_u32 s66, s66, 3584
    buffer_load_dwordx4 v[88:91], v10, s[52:55], s66 offen nt
    s_add_u32 s66, s66, 3584
    buffer_load_dwordx4 v[92:95], v10, s[52:55], s66 offen nt
    s_waitcnt vmcnt(8)
    v_lshlrev_b32 v128, 16, v16
    v_and_b32 v129, 0xffff0000, v16
    v_lshlrev_b32 v130, 16, v17
    v_and_b32 v131, 0xffff0000, v17
    v_lshlrev_b32 v132, 16, v18
    v_and_b32 v133, 0xffff0000, v18
    v_lshlrev_b32 v134, 16, v19
    v_and_b32 v135, 0xffff0000, v19
    v_lshlrev_b32 v136, 16, v20
    v_and_b32 v137, 0xffff0000, v20
    v_lshlrev_b32 v138, 16, v21
    v_and_b32 v139, 0xffff0000, v21
    v_lshlrev_b32 v140, 16, v22
    v_and_b32 v141, 0xffff0000, v22
    v_lshlrev_b32 v142, 16, v23
    v_and_b32 v143, 0xffff0000, v23
    v_add_f32 v144, v128, v129
    v_add_f32 v144, v144, v130
    v_add_f32 v144, v144, v131
    v_add_f32 v144, v144, v132
    v_add_f32 v144, v144, v133
    v_add_f32 v144, v144, v134
    v_add_f32 v144, v144, v135
    v_add_f32 v145, v136, v137
    v_add_f32 v145, v145, v138
    v_add_f32 v145, v145, v139
    v_add_f32 v145, v145, v140
    v_add_f32 v145, v145, v141
    v_add_f32 v145, v145, v142
    v_add_f32 v145, v145, v143
    s_nop 1
    v_add_f32_dpp v144, v144, v144 quad_perm:[1,0,3,2] row_mask:0xf bank_mask:0xf
    v_add_f32_dpp v145, v145, v145 quad_perm:[1,0,3,2] row_mask:0xf bank_mask:0xf
    s_nop 1
    v_add_f32_dpp v144, v144, v144 quad_perm:[2,3,0,1] row_mask:0xf bank_mask:0xf
    v_add_f32_dpp v145, v145, v145 quad_perm:[2,3,0,1] row_mask:0xf bank_mask:0xf
    s_nop 1
    v_add_f32_dpp v144, v144, v144 row_ror:4 row_mask:0xf bank_mask:0xf
    v_add_f32_dpp v145, v145, v145 row_ror:4 row_mask:0xf bank_mask:0xf
    s_nop 1
    v_add_f32_dpp v144, v144, v144 row_ror:8 row_mask:0xf bank_mask:0xf
    v_add_f32_dpp v145, v145, v145 row_ror:8 row_mask:0xf bank_mask:0xf
    v_mov_b32 v146, v144
    v_mov_b32 v147, v145
    s_nop 1
    v_permlane16_swap_b32 v144, v146
    v_permlane16_swap_b32 v145, v147
    s_nop 0
    v_add_f32 v144, v144, v146
    v_add_f32 v145, v145, v147
    v_mov_b32 v146, v144
    v_mov_b32 v147, v145
    s_nop 1
    v_permlane32_swap_b32 v144, v146
    v_permlane32_swap_b32 v145, v147
    s_nop 0
    v_add_f32 v144, v144, v146
    v_add_f32 v145, v145, v147
    v_mul_f32 v144, 0x3b000000, v144
    v_mul_f32 v145, 0x3b000000, v145
    v_sub_f32 v150, v128, v144
    v_mul_f32 v148, v150, v150
    v_sub_f32 v150, v129, v144
    v_fmac_f32 v148, v150, v150
    v_sub_f32 v150, v130, v144
    v_fmac_f32 v148, v150, v150
    v_sub_f32 v150, v131, v144
    v_fmac_f32 v148, v150, v150
    v_sub_f32 v150, v132, v144
    v_fmac_f32 v148, v150, v150
    v_sub_f32 v150, v133, v144
    v_fmac_f32 v148, v150, v150
    v_sub_f32 v150, v134, v144
    v_fmac_f32 v148, v150, v150
    v_sub_f32 v150, v135, v144
    v_fmac_f32 v148, v150, v150
    v_sub_f32 v150, v136, v145
    v_mul_f32 v149, v150, v150
    v_sub_f32 v150, v137, v145
    v_fmac_f32 v149, v150, v150
    v_sub_f32 v150, v138, v145
    v_fmac_f32 v149, v150, v150
    v_sub_f32 v150, v139, v145
    v_fmac_f32 v149, v150, v150
    v_sub_f32 v150, v140, v145
    v_fmac_f32 v149, v150, v150
    v_sub_f32 v150, v141, v145
    v_fmac_f32 v149, v150, v150
    v_sub_f32 v150, v142, v145
    v_fmac_f32 v149, v150, v150
    v_sub_f32 v150, v143, v145
    v_fmac_f32 v149, v150, v150
    s_nop 1
    v_add_f32_dpp v148, v148, v148 quad_perm:[1,0,3,2] row_mask:0xf bank_mask:0xf
    v_add_f32_dpp v149, v149, v149 quad_perm:[1,0,3,2] row_mask:0xf bank_mask:0xf
    s_nop 1
    v_add_f32_dpp v148, v148, v148 quad_perm:[2,3,0,1] row_mask:0xf bank_mask:0xf
    v_add_f32_dpp v149, v149, v149 quad_perm:[2,3,0,1] row_mask:0xf bank_mask:0xf
    s_nop 1
    v_add_f32_dpp v148, v148, v148 row_ror:4 row_mask:0xf bank_mask:0xf
    v_add_f32_dpp v149, v149, v149 row_ror:4 row_mask:0xf bank_mask:0xf
    s_nop 1
    v_add_f32_dpp v148, v148, v148 row_ror:8 row_mask:0xf bank_mask:0xf
    v_add_f32_dpp v149, v149, v149 row_ror:8 row_mask:0xf bank_mask:0xf
    v_mov_b32 v146, v148
    v_mov_b32 v147, v149
    s_nop 1
    v_permlane16_swap_b32 v148, v146
    v_permlane16_swap_b32 v149, v147
    s_nop 0
    v_add_f32 v148, v148, v146
    v_add_f32 v149, v149, v147
    v_mov_b32 v146, v148
    v_mov_b32 v147, v149
    s_nop 1
    v_permlane32_swap_b32 v148, v146
    v_permlane32_swap_b32 v149, v147
    s_nop 0
    v_add_f32 v148, v148, v146
    v_add_f32 v149, v149, v147
    v_mul_f32 v148, 0x3b000000, v148
    v_mul_f32 v149, 0x3b000000, v149
    v_cvt_pk_bf16_f32 v150, v144, v148
    v_lshlrev_b32 v144, 16, v150
    v_and_b32 v148, 0xffff0000, v150
    v_add_f32 v148, 0x3727c5ac, v148
    v_cvt_pk_bf16_f32 v150, v148, v148
    v_lshlrev_b32 v148, 16, v150
    v_sqrt_f32 v148, v148
    s_nop 0
    v_cvt_pk_bf16_f32 v150, v148, v148
    v_lshlrev_b32 v148, 16, v150
    v_rcp_f32 v151, v148
    v_cvt_pk_bf16_f32 v150, v145, v149
    v_lshlrev_b32 v145, 16, v150
    v_and_b32 v149, 0xffff0000, v150
    v_add_f32 v149, 0x3727c5ac, v149
    v_cvt_pk_bf16_f32 v150, v149, v149
    v_lshlrev_b32 v149, 16, v150
    v_sqrt_f32 v149, v149
    s_nop 0
    v_cvt_pk_bf16_f32 v150, v149, v149
    v_lshlrev_b32 v149, 16, v150
    v_rcp_f32 v152, v149
    s_nop 0
    v_sub_f32 v128, v128, v144
    v_sub_f32 v129, v129, v144
    v_cvt_pk_bf16_f32 v150, v128, v129
    v_lshlrev_b32 v128, 16, v150
    v_and_b32 v129, 0xffff0000, v150
    v_mul_f32 v153, v128, v151
    v_mul_f32 v154, v129, v151
    v_fma_f32 v155, -v153, v148, v128
    v_fma_f32 v156, -v154, v148, v129
    v_fmac_f32 v153, v155, v151
    v_fmac_f32 v154, v156, v151
    v_cvt_pk_bf16_f32 v150, v153, v154
    v_and_b32 v128, 0xffff, v150
    v_lshrrev_b32 v129, 16, v150
    v_sub_f32 v130, v130, v144
    v_sub_f32 v131, v131, v144
    v_cvt_pk_bf16_f32 v150, v130, v131
    v_lshlrev_b32 v130, 16, v150
    v_and_b32 v131, 0xffff0000, v150
    v_mul_f32 v153, v130, v151
    v_mul_f32 v154, v131, v151
    v_fma_f32 v155, -v153, v148, v130
    v_fma_f32 v156, -v154, v148, v131
    v_fmac_f32 v153, v155, v151
    v_fmac_f32 v154, v156, v151
    v_cvt_pk_bf16_f32 v150, v153, v154
    v_and_b32 v130, 0xffff, v150
    v_lshrrev_b32 v131, 16, v150
    v_sub_f32 v132, v132, v144
    v_sub_f32 v133, v133, v144
    v_cvt_pk_bf16_f32 v150, v132, v133
    v_lshlrev_b32 v132, 16, v150
    v_and_b32 v133, 0xffff0000, v150
    v_mul_f32 v153, v132, v151
    v_mul_f32 v154, v133, v151
    v_fma_f32 v155, -v153, v148, v132
    v_fma_f32 v156, -v154, v148, v133
    v_fmac_f32 v153, v155, v151
    v_fmac_f32 v154, v156, v151
    v_cvt_pk_bf16_f32 v150, v153, v154
    v_and_b32 v132, 0xffff, v150
    v_lshrrev_b32 v133, 16, v150
    v_sub_f32 v134, v134, v144
    v_sub_f32 v135, v135, v144
    v_cvt_pk_bf16_f32 v150, v134, v135
    v_lshlrev_b32 v134, 16, v150
    v_and_b32 v135, 0xffff0000, v150
    v_mul_f32 v153, v134, v151
    v_mul_f32 v154, v135, v151
    v_fma_f32 v155, -v153, v148, v134
    v_fma_f32 v156, -v154, v148, v135
    v_fmac_f32 v153, v155, v151
    v_fmac_f32 v154, v156, v151
    v_cvt_pk_bf16_f32 v150, v153, v154
    v_and_b32 v134, 0xffff, v150
    v_lshrrev_b32 v135, 16, v150
    v_sub_f32 v136, v136, v145
    v_sub_f32 v137, v137, v145
    v_cvt_pk_bf16_f32 v150, v136, v137
    v_lshlrev_b32 v136, 16, v150
    v_and_b32 v137, 0xffff0000, v150
    v_mul_f32 v153, v136, v152
    v_mul_f32 v154, v137, v152
    v_fma_f32 v155, -v153, v149, v136
    v_fma_f32 v156, -v154, v149, v137
    v_fmac_f32 v153, v155, v152
    v_fmac_f32 v154, v156, v152
    v_cvt_pk_bf16_f32 v150, v153, v154
    v_and_b32 v136, 0xffff, v150
    v_lshrrev_b32 v137, 16, v150
    v_sub_f32 v138, v138, v145
    v_sub_f32 v139, v139, v145
    v_cvt_pk_bf16_f32 v150, v138, v139
    v_lshlrev_b32 v138, 16, v150
    v_and_b32 v139, 0xffff0000, v150
    v_mul_f32 v153, v138, v152
    v_mul_f32 v154, v139, v152
    v_fma_f32 v155, -v153, v149, v138
    v_fma_f32 v156, -v154, v149, v139
    v_fmac_f32 v153, v155, v152
    v_fmac_f32 v154, v156, v152
    v_cvt_pk_bf16_f32 v150, v153, v154
    v_and_b32 v138, 0xffff, v150
    v_lshrrev_b32 v139, 16, v150
    v_sub_f32 v140, v140, v145
    v_sub_f32 v141, v141, v145
    v_cvt_pk_bf16_f32 v150, v140, v141
    v_lshlrev_b32 v140, 16, v150
    v_and_b32 v141, 0xffff0000, v150
    v_mul_f32 v153, v140, v152
    v_mul_f32 v154, v141, v152
    v_fma_f32 v155, -v153, v149, v140
    v_fma_f32 v156, -v154, v149, v141
    v_fmac_f32 v153, v155, v152
    v_fmac_f32 v154, v156, v152
    v_cvt_pk_bf16_f32 v150, v153, v154
    v_and_b32 v140, 0xffff, v150
    v_lshrrev_b32 v141, 16, v150
    v_sub_f32 v142, v142, v145
    v_sub_f32 v143, v143, v145
    v_cvt_pk_bf16_f32 v150, v142, v143
    v_lshlrev_b32 v142, 16, v150
    v_and_b32 v143, 0xffff0000, v150
    v_mul_f32 v153, v142, v152
    v_mul_f32 v154, v143, v152
    v_fma_f32 v155, -v153, v149, v142
    v_fma_f32 v156, -v154, v149, v143
    v_fmac_f32 v153, v155, v152
    v_fmac_f32 v154, v156, v152
    v_cvt_pk_bf16_f32 v150, v153, v154
    v_and_b32 v142, 0xffff, v150
    v_lshrrev_b32 v143, 16, v150
    s_lshl_b32 s64, s81, 3
    v_add_u32 v12, s64, v8
    v_lshlrev_b32 v12, 2, v12
    ds_bpermute_b32 v160, v12, v128
    ds_bpermute_b32 v161, v12, v129
    ds_bpermute_b32 v162, v12, v130
    ds_bpermute_b32 v163, v12, v131
    ds_bpermute_b32 v164, v12, v132
    ds_bpermute_b32 v165, v12, v133
    ds_bpermute_b32 v166, v12, v134
    ds_bpermute_b32 v167, v12, v135
    s_waitcnt lgkmcnt(4)
    ds_bpermute_b32 v168, v12, v136
    ds_bpermute_b32 v169, v12, v137
    ds_bpermute_b32 v170, v12, v138
    ds_bpermute_b32 v171, v12, v139
    ds_bpermute_b32 v172, v12, v140
    ds_bpermute_b32 v173, v12, v141
    ds_bpermute_b32 v174, v12, v142
    ds_bpermute_b32 v175, v12, v143
    v_mov_b32 v96, 0
    v_mov_b32 v97, 0
    v_mov_b32 v98, 0
    v_mov_b32 v99, 0
    v_mov_b32 v100, 0
    v_mov_b32 v101, 0
    v_mov_b32 v102, 0
    v_mov_b32 v103, 0
    v_mov_b32 v104, 0
    v_mov_b32 v105, 0
    v_mov_b32 v106, 0
    v_mov_b32 v107, 0
    v_mov_b32 v108, 0
    v_mov_b32 v109, 0
    v_mov_b32 v110, 0
    v_mov_b32 v111, 0
    s_waitcnt lgkmcnt(0)
    v_lshlrev_b32 v176, 16, v160
    v_lshlrev_b32 v177, 16, v161
    v_lshlrev_b32 v178, 16, v162
    v_lshlrev_b32 v179, 16, v163
    v_lshlrev_b32 v180, 16, v164
    v_lshlrev_b32 v181, 16, v165
    v_lshlrev_b32 v182, 16, v166
    v_lshlrev_b32 v183, 16, v167
    v_lshlrev_b32 v184, 16, v168
    v_lshlrev_b32 v185, 16, v169
    v_lshlrev_b32 v186, 16, v170
    v_lshlrev_b32 v187, 16, v171
    v_lshlrev_b32 v188, 16, v172
    v_lshlrev_b32 v189, 16, v173
    v_lshlrev_b32 v190, 16, v174
    v_lshlrev_b32 v191, 16, v175
    s_waitcnt vmcnt(0)
    v_dot2_f32_bf16 v96, v64, v160, v96
    v_dot2_f32_bf16 v97, v64, v176, v97
    v_dot2_f32_bf16 v104, v64, v168, v104
    v_dot2_f32_bf16 v105, v64, v184, v105
    v_dot2_f32_bf16 v98, v65, v160, v98
    v_dot2_f32_bf16 v99, v65, v176, v99
    v_dot2_f32_bf16 v106, v65, v168, v106
    v_dot2_f32_bf16 v107, v65, v184, v107
    v_dot2_f32_bf16 v100, v66, v160, v100
    v_dot2_f32_bf16 v101, v66, v176, v101
    v_dot2_f32_bf16 v108, v66, v168, v108
    v_dot2_f32_bf16 v109, v66, v184, v109
    v_dot2_f32_bf16 v102, v67, v160, v102
    v_dot2_f32_bf16 v103, v67, v176, v103
    v_dot2_f32_bf16 v110, v67, v168, v110
    v_dot2_f32_bf16 v111, v67, v184, v111
    v_dot2_f32_bf16 v96, v68, v161, v96
    v_dot2_f32_bf16 v97, v68, v177, v97
    v_dot2_f32_bf16 v104, v68, v169, v104
    v_dot2_f32_bf16 v105, v68, v185, v105
    v_dot2_f32_bf16 v98, v69, v161, v98
    v_dot2_f32_bf16 v99, v69, v177, v99
    v_dot2_f32_bf16 v106, v69, v169, v106
    v_dot2_f32_bf16 v107, v69, v185, v107
    v_dot2_f32_bf16 v100, v70, v161, v100
    v_dot2_f32_bf16 v101, v70, v177, v101
    v_dot2_f32_bf16 v108, v70, v169, v108
    v_dot2_f32_bf16 v109, v70, v185, v109
    v_dot2_f32_bf16 v102, v71, v161, v102
    v_dot2_f32_bf16 v103, v71, v177, v103
    v_dot2_f32_bf16 v110, v71, v169, v110
    v_dot2_f32_bf16 v111, v71, v185, v111
    v_dot2_f32_bf16 v96, v72, v162, v96
    v_dot2_f32_bf16 v97, v72, v178, v97
    v_dot2_f32_bf16 v104, v72, v170, v104
    v_dot2_f32_bf16 v105, v72, v186, v105
    v_dot2_f32_bf16 v98, v73, v162, v98
    v_dot2_f32_bf16 v99, v73, v178, v99
    v_dot2_f32_bf16 v106, v73, v170, v106
    v_dot2_f32_bf16 v107, v73, v186, v107
    v_dot2_f32_bf16 v100, v74, v162, v100
    v_dot2_f32_bf16 v101, v74, v178, v101
    v_dot2_f32_bf16 v108, v74, v170, v108
    v_dot2_f32_bf16 v109, v74, v186, v109
    v_dot2_f32_bf16 v102, v75, v162, v102
    v_dot2_f32_bf16 v103, v75, v178, v103
    v_dot2_f32_bf16 v110, v75, v170, v110
    v_dot2_f32_bf16 v111, v75, v186, v111
    v_dot2_f32_bf16 v96, v76, v163, v96
    v_dot2_f32_bf16 v97, v76, v179, v97
    v_dot2_f32_bf16 v104, v76, v171, v104
    v_dot2_f32_bf16 v105, v76, v187, v105
    v_dot2_f32_bf16 v98, v77, v163, v98
    v_dot2_f32_bf16 v99, v77, v179, v99
    v_dot2_f32_bf16 v106, v77, v171, v106
    v_dot2_f32_bf16 v107, v77, v187, v107
    v_dot2_f32_bf16 v100, v78, v163, v100
    v_dot2_f32_bf16 v101, v78, v179, v101
    v_dot2_f32_bf16 v108, v78, v171, v108
    v_dot2_f32_bf16 v109, v78, v187, v109
    v_dot2_f32_bf16 v102, v79, v163, v102
    v_dot2_f32_bf16 v103, v79, v179, v103
    v_dot2_f32_bf16 v110, v79, v171, v110
    v_dot2_f32_bf16 v111, v79, v187, v111
    v_dot2_f32_bf16 v96, v80, v164, v96
    v_dot2_f32_bf16 v97, v80, v180, v97
    v_dot2_f32_bf16 v104, v80, v172, v104
    v_dot2_f32_bf16 v105, v80, v188, v105
    v_dot2_f32_bf16 v98, v81, v164, v98
    v_dot2_f32_bf16 v99, v81, v180, v99
    v_dot2_f32_bf16 v106, v81, v172, v106
    v_dot2_f32_bf16 v107, v81, v188, v107
    v_dot2_f32_bf16 v100, v82, v164, v100
    v_dot2_f32_bf16 v101, v82, v180, v101
    v_dot2_f32_bf16 v108, v82, v172, v108
    v_dot2_f32_bf16 v109, v82, v188, v109
    v_dot2_f32_bf16 v102, v83, v164, v102
    v_dot2_f32_bf16 v103, v83, v180, v103
    v_dot2_f32_bf16 v110, v83, v172, v110
    v_dot2_f32_bf16 v111, v83, v188, v111
    v_dot2_f32_bf16 v96, v84, v165, v96
    v_dot2_f32_bf16 v97, v84, v181, v97
    v_dot2_f32_bf16 v104, v84, v173, v104
    v_dot2_f32_bf16 v105, v84, v189, v105
    v_dot2_f32_bf16 v98, v85, v165, v98
    v_dot2_f32_bf16 v99, v85, v181, v99
    v_dot2_f32_bf16 v106, v85, v173, v106
    v_dot2_f32_bf16 v107, v85, v189, v107
    v_dot2_f32_bf16 v100, v86, v165, v100
    v_dot2_f32_bf16 v101, v86, v181, v101
    v_dot2_f32_bf16 v108, v86, v173, v108
    v_dot2_f32_bf16 v109, v86, v189, v109
    v_dot2_f32_bf16 v102, v87, v165, v102
    v_dot2_f32_bf16 v103, v87, v181, v103
    v_dot2_f32_bf16 v110, v87, v173, v110
    v_dot2_f32_bf16 v111, v87, v189, v111
    v_dot2_f32_bf16 v96, v88, v166, v96
    v_dot2_f32_bf16 v97, v88, v182, v97
    v_dot2_f32_bf16 v104, v88, v174, v104
    v_dot2_f32_bf16 v105, v88, v190, v105
    v_dot2_f32_bf16 v98, v89, v166, v98
    v_dot2_f32_bf16 v99, v89, v182, v99
    v_dot2_f32_bf16 v106, v89, v174, v106
    v_dot2_f32_bf16 v107, v89, v190, v107
    v_dot2_f32_bf16 v100, v90, v166, v100
    v_dot2_f32_bf16 v101, v90, v182, v101
    v_dot2_f32_bf16 v108, v90, v174, v108
    v_dot2_f32_bf16 v109, v90, v190, v109
    v_dot2_f32_bf16 v102, v91, v166, v102
    v_dot2_f32_bf16 v103, v91, v182, v103
    v_dot2_f32_bf16 v110, v91, v174, v110
    v_dot2_f32_bf16 v111, v91, v190, v111
    v_dot2_f32_bf16 v96, v92, v167, v96
    v_dot2_f32_bf16 v97, v92, v183, v97
    v_dot2_f32_bf16 v104, v92, v175, v104
    v_dot2_f32_bf16 v105, v92, v191, v105
    v_dot2_f32_bf16 v98, v93, v167, v98
    v_dot2_f32_bf16 v99, v93, v183, v99
    v_dot2_f32_bf16 v106, v93, v175, v106
    v_dot2_f32_bf16 v107, v93, v191, v107
    v_dot2_f32_bf16 v100, v94, v167, v100
    v_dot2_f32_bf16 v101, v94, v183, v101
    v_dot2_f32_bf16 v108, v94, v175, v108
    v_dot2_f32_bf16 v109, v94, v191, v109
    v_dot2_f32_bf16 v102, v95, v167, v102
    v_dot2_f32_bf16 v103, v95, v183, v103
    v_dot2_f32_bf16 v110, v95, v175, v110
    v_dot2_f32_bf16 v111, v95, v191, v111
    s_nop 3
    s_nop 1
    v_permlane32_swap_b32 v96, v104
    v_permlane32_swap_b32 v97, v105
    v_permlane32_swap_b32 v98, v106
    v_permlane32_swap_b32 v99, v107
    v_permlane32_swap_b32 v100, v108
    v_permlane32_swap_b32 v101, v109
    v_permlane32_swap_b32 v102, v110
    v_permlane32_swap_b32 v103, v111
    s_nop 0
    v_add_f32 v96, v96, v104
    v_add_f32 v97, v97, v105
    v_add_f32 v98, v98, v106
    v_add_f32 v99, v99, v107
    v_add_f32 v100, v100, v108
    v_add_f32 v101, v101, v109
    v_add_f32 v102, v102, v110
    v_add_f32 v103, v103, v111
    s_nop 1
    v_permlane16_swap_b32 v96, v100
    v_permlane16_swap_b32 v97, v101
    v_permlane16_swap_b32 v98, v102
    v_permlane16_swap_b32 v99, v103
    s_nop 0
    v_add_f32 v96, v96, v100
    v_add_f32 v97, v97, v101
    v_add_f32 v98, v98, v102
    v_add_f32 v99, v99, v103
    s_nop 1
    v_add_f32_dpp v96, v96, v96 row_ror:8 row_mask:0xf bank_mask:0xf
    v_add_f32_dpp v97, v97, v97 row_ror:8 row_mask:0xf bank_mask:0xf
    v_add_f32_dpp v98, v98, v98 row_ror:8 row_mask:0xf bank_mask:0xf
    v_add_f32_dpp v99, v99, v99 row_ror:8 row_mask:0xf bank_mask:0xf
    v_lshrrev_b32 v11, 1, v3
    v_lshlrev_b32 v11, 8, v11
    v_and_b32 v12, 1, v3
    v_lshl_add_u32 v11, v12, 4, v11
    v_lshl_add_u32 v11, v9, 5, v11
    s_mov_b32 s82, 0
LW_44:
    ds_read_b32 v25, v24 offset:40
    s_waitcnt lgkmcnt(0)
    v_readfirstlane_b32 s33, v25
    s_add_u32 s82, s82, 1
    s_cmp_ge_u32 s33, 1
    s_cbranch_scc1 LG_45
    s_sleep 8
    s_cmp_lt_u32 s82, 0x800000
    s_cbranch_scc1 LW_44
LG_45:
    s_lshl_b32 s66, s74, 9
    s_add_u32 s66, s66, s34
    s_add_u32 s66, s66, 4096
    v_and_b32 v12, 8, v1
    v_cmp_eq_u32 vcc, 0, v12
    s_and_saveexec_b64 s[64:65], vcc
    buffer_store_dwordx4 v[96:99], v11, s[36:39], s66 offen sc1
    s_mov_b64 exec, s[64:65]
H67_noffn1:
    s_and_b32 s64, s2, 31
    s_cmp_ge_u32 s64, 28
    s_cbranch_scc1 H6_fred
    s_mov_b32 s52, s20
    s_mov_b32 s53, s21
    s_mov_b32 s54, 1835008
    s_mov_b32 s55, 0x00020000
    v_lshlrev_b32 v10, 12, v8
    v_lshl_add_u32 v10, v9, 4, v10
    s_lshl_b32 s66, s64, 16
    s_lshl_b32 s67, s74, 15
    s_add_u32 s66, s66, s67
    s_add_u32 s66, s66, s63
    buffer_load_dwordx4 v[48:51], v10, s[52:55], s66 offen offset:0 nt
    buffer_load_dwordx4 v[52:55], v10, s[52:55], s66 offen offset:1024 nt
    buffer_load_dwordx4 v[56:59], v10, s[52:55], s66 offen offset:2048 nt
    buffer_load_dwordx4 v[60:63], v10, s[52:55], s66 offen offset:3072 nt
    s_mov_b32 s82, 0
LW_46:
    ds_read_b32 v25, v24 offset:40
    s_waitcnt lgkmcnt(0)
    v_readfirstlane_b32 s33, v25
    s_add_u32 s82, s82, 1
    s_cmp_ge_u32 s33, 1
    s_cbranch_scc1 LG_47
    s_sleep 8
    s_cmp_lt_u32 s82, 0x800000
    s_cbranch_scc1 LW_46
LG_47:
    s_mov_b32 s82, 0
LW_48:
    ds_read_b32 v25, v24 offset:0
    s_waitcnt lgkmcnt(0)
    v_readfirstlane_b32 s33, v25
    s_add_u32 s82, s82, 1
    s_cmp_ge_u32 s33, 56
    s_cbranch_scc1 LG_49
    s_sleep 8
    s_cmp_lt_u32 s82, 0x800000
    s_cbranch_scc1 LW_48
LG_49:
    v_lshlrev_b32 v11, 4, v8
    s_lshl_b32 s66, s64, 16
    s_lshl_b32 s67, s74, 7
    s_add_u32 s66, s66, s67
    s_add_u32 s66, s66, 4096
    v_add_u32 v201, 8192, v11
    v_add_u32 v202, 16384, v11
    v_add_u32 v203, 24576, v11
    v_add_u32 v204, 32768, v11
    v_add_u32 v205, 40960, v11
    v_add_u32 v206, 49152, v11
    v_add_u32 v207, 57344, v11
    s_mov_b32 s68, 0
PL_50:
    buffer_load_dwordx4 v[64:67], v11, s[36:39], s66 offen offset:0 sc1
    buffer_load_dwordx4 v[68:71], v11, s[36:39], s66 offen offset:256 sc1
    buffer_load_dwordx4 v[72:75], v11, s[36:39], s66 offen offset:512 sc1
    buffer_load_dwordx4 v[76:79], v11, s[36:39], s66 offen offset:768 sc1
    buffer_load_dwordx4 v[80:83], v201, s[36:39], s66 offen offset:0 sc1
    buffer_load_dwordx4 v[84:87], v201, s[36:39], s66 offen offset:256 sc1
    buffer_load_dwordx4 v[88:91], v201, s[36:39], s66 offen offset:512 sc1
    buffer_load_dwordx4 v[92:95], v201, s[36:39], s66 offen offset:768 sc1
    buffer_load_dwordx4 v[96:99], v202, s[36:39], s66 offen offset:0 sc1
    buffer_load_dwordx4 v[100:103], v202, s[36:39], s66 offen offset:256 sc1
    buffer_load_dwordx4 v[104:107], v202, s[36:39], s66 offen offset:512 sc1
    buffer_load_dwordx4 v[108:111], v202, s[36:39], s66 offen offset:768 sc1
    buffer_load_dwordx4 v[112:115], v203, s[36:39], s66 offen offset:0 sc1
    buffer_load_dwordx4 v[116:119], v203, s[36:39], s66 offen offset:256 sc1
    buffer_load_dwordx4 v[120:123], v203, s[36:39], s66 offen offset:512 sc1
    buffer_load_dwordx4 v[124:127], v203, s[36:39], s66 offen offset:768 sc1
    buffer_load_dwordx4 v[128:131], v204, s[36:39], s66 offen offset:0 sc1
    buffer_load_dwordx4 v[132:135], v204, s[36:39], s66 offen offset:256 sc1
    buffer_load_dwordx4 v[136:139], v204, s[36:39], s66 offen offset:512 sc1
    buffer_load_dwordx4 v[140:143], v204, s[36:39], s66 offen offset:768 sc1
    buffer_load_dwordx4 v[144:147], v205, s[36:39], s66 offen offset:0 sc1
    buffer_load_dwordx4 v[148:151], v205, s[36:39], s66 offen offset:256 sc1
    buffer_load_dwordx4 v[152:155], v205, s[36:39], s66 offen offset:512 sc1
    buffer_load_dwordx4 v[156:159], v205, s[36:39], s66 offen offset:768 sc1
    buffer_load_dwordx4 v[160:163], v206, s[36:39], s66 offen offset:0 sc1
    buffer_load_dwordx4 v[164:167], v206, s[36:39], s66 offen offset:256 sc1
    buffer_load_dwordx4 v[168:171], v206, s[36:39], s66 offen offset:512 sc1
    buffer_load_dwordx4 v[172:175], v206, s[36:39], s66 offen offset:768 sc1
    buffer_load_dwordx4 v[176:179], v207, s[36:39], s66 offen offset:0 sc1
    buffer_load_dwordx4 v[180:183], v207, s[36:39], s66 offen offset:256 sc1
    buffer_load_dwordx4 v[184:187], v207, s[36:39], s66 offen offset:512 sc1
    buffer_load_dwordx4 v[188:191], v207, s[36:39], s66 offen offset:768 sc1
    s_waitcnt vmcnt(0)
    v_mov_b32 v28, v64
    v_max3_u32 v28, v28, v65, v66
    v_max3_u32 v28, v28, v67, v68
    v_max3_u32 v28, v28, v69, v70
    v_max3_u32 v28, v28, v71, v72
    v_max3_u32 v28, v28, v73, v74
    v_max3_u32 v28, v28, v75, v76
    v_max3_u32 v28, v28, v77, v78
    v_max3_u32 v28, v28, v79, v80
    v_max3_u32 v28, v28, v81, v82
    v_max3_u32 v28, v28, v83, v84
    v_max3_u32 v28, v28, v85, v86
    v_max3_u32 v28, v28, v87, v88
    v_max3_u32 v28, v28, v89, v90
    v_max3_u32 v28, v28, v91, v92
    v_max3_u32 v28, v28, v93, v94
    v_max3_u32 v28, v28, v95, v96
    v_max3_u32 v28, v28, v97, v98
    v_max3_u32 v28, v28, v99, v100
    v_max3_u32 v28, v28, v101, v102
    v_max3_u32 v28, v28, v103, v104
    v_max3_u32 v28, v28, v105, v106
    v_max3_u32 v28, v28, v107, v108
    v_max3_u32 v28, v28, v109, v110
    v_max3_u32 v28, v28, v111, v112
    v_max3_u32 v28, v28, v113, v114
    v_max3_u32 v28, v28, v115, v116
    v_max3_u32 v28, v28, v117, v118
    v_max3_u32 v28, v28, v119, v120
    v_max3_u32 v28, v28, v121, v122
    v_max3_u32 v28, v28, v123, v124
    v_max3_u32 v28, v28, v125, v126
    v_max3_u32 v28, v28, v127, v128
    v_max3_u32 v28, v28, v129, v130
    v_max3_u32 v28, v28, v131, v132
    v_max3_u32 v28, v28, v133, v134
    v_max3_u32 v28, v28, v135, v136
    v_max3_u32 v28, v28, v137, v138
    v_max3_u32 v28, v28, v139, v140
    v_max3_u32 v28, v28, v141, v142
    v_max3_u32 v28, v28, v143, v144
    v_max3_u32 v28, v28, v145, v146
    v_max3_u32 v28, v28, v147, v148
    v_max3_u32 v28, v28, v149, v150
    v_max3_u32 v28, v28, v151, v152
    v_max3_u32 v28, v28, v153, v154
    v_max3_u32 v28, v28, v155, v156
    v_max3_u32 v28, v28, v157, v158
    v_max3_u32 v28, v28, v159, v160
    v_max3_u32 v28, v28, v161, v162
    v_max3_u32 v28, v28, v163, v164
    v_max3_u32 v28, v28, v165, v166
    v_max3_u32 v28, v28, v167, v168
    v_max3_u32 v28, v28, v169, v170
    v_max3_u32 v28, v28, v171, v172
    v_max3_u32 v28, v28, v173, v174
    v_max3_u32 v28, v28, v175, v176
    v_max3_u32 v28, v28, v177, v178
    v_max3_u32 v28, v28, v179, v180
    v_max3_u32 v28, v28, v181, v182
    v_max3_u32 v28, v28, v183, v184
    v_max3_u32 v28, v28, v185, v186
    v_max3_u32 v28, v28, v187, v188
    v_max3_u32 v28, v28, v189, v190
    v_max_u32 v28, v28, v191
    v_cmp_eq_u32 vcc, -1, v28
    s_add_u32 s68, s68, 1
    s_cmp_eq_u64 vcc, 0
    s_cbranch_scc1 PG_51
    s_sleep 48
    s_cmp_lt_u32 s68, 400000
    s_cbranch_scc1 PL_50
PG_51:
    v_add_f32 v64, v64, v80
    v_add_f32 v65, v65, v81
    v_add_f32 v66, v66, v82
    v_add_f32 v67, v67, v83
    v_add_f32 v68, v68, v84
    v_add_f32 v69, v69, v85
    v_add_f32 v70, v70, v86
    v_add_f32 v71, v71, v87
    v_add_f32 v72, v72, v88
    v_add_f32 v73, v73, v89
    v_add_f32 v74, v74, v90
    v_add_f32 v75, v75, v91
    v_add_f32 v76, v76, v92
    v_add_f32 v77, v77, v93
    v_add_f32 v78, v78, v94
    v_add_f32 v79, v79, v95
    v_add_f32 v64, v64, v96
    v_add_f32 v65, v65, v97
    v_add_f32 v66, v66, v98
    v_add_f32 v67, v67, v99
    v_add_f32 v68, v68, v100
    v_add_f32 v69, v69, v101
    v_add_f32 v70, v70, v102
    v_add_f32 v71, v71, v103
    v_add_f32 v72, v72, v104
    v_add_f32 v73, v73, v105
    v_add_f32 v74, v74, v106
    v_add_f32 v75, v75, v107
    v_add_f32 v76, v76, v108
    v_add_f32 v77, v77, v109
    v_add_f32 v78, v78, v110
    v_add_f32 v79, v79, v111
    v_add_f32 v64, v64, v112
    v_add_f32 v65, v65, v113
    v_add_f32 v66, v66, v114
    v_add_f32 v67, v67, v115
    v_add_f32 v68, v68, v116
    v_add_f32 v69, v69, v117
    v_add_f32 v70, v70, v118
    v_add_f32 v71, v71, v119
    v_add_f32 v72, v72, v120
    v_add_f32 v73, v73, v121
    v_add_f32 v74, v74, v122
    v_add_f32 v75, v75, v123
    v_add_f32 v76, v76, v124
    v_add_f32 v77, v77, v125
    v_add_f32 v78, v78, v126
    v_add_f32 v79, v79, v127
    v_add_f32 v64, v64, v128
    v_add_f32 v65, v65, v129
    v_add_f32 v66, v66, v130
    v_add_f32 v67, v67, v131
    v_add_f32 v68, v68, v132
    v_add_f32 v69, v69, v133
    v_add_f32 v70, v70, v134
    v_add_f32 v71, v71, v135
    v_add_f32 v72, v72, v136
    v_add_f32 v73, v73, v137
    v_add_f32 v74, v74, v138
    v_add_f32 v75, v75, v139
    v_add_f32 v76, v76, v140
    v_add_f32 v77, v77, v141
    v_add_f32 v78, v78, v142
    v_add_f32 v79, v79, v143
    v_add_f32 v64, v64, v144
    v_add_f32 v65, v65, v145
    v_add_f32 v66, v66, v146
    v_add_f32 v67, v67, v147
    v_add_f32 v68, v68, v148
    v_add_f32 v69, v69, v149
    v_add_f32 v70, v70, v150
    v_add_f32 v71, v71, v151
    v_add_f32 v72, v72, v152
    v_add_f32 v73, v73, v153
    v_add_f32 v74, v74, v154
    v_add_f32 v75, v75, v155
    v_add_f32 v76, v76, v156
    v_add_f32 v77, v77, v157
    v_add_f32 v78, v78, v158
    v_add_f32 v79, v79, v159
    v_add_f32 v64, v64, v160
    v_add_f32 v65, v65, v161
    v_add_f32 v66, v66, v162
    v_add_f32 v67, v67, v163
    v_add_f32 v68, v68, v164
    v_add_f32 v69, v69, v165
    v_add_f32 v70, v70, v166
    v_add_f32 v71, v71, v167
    v_add_f32 v72, v72, v168
    v_add_f32 v73, v73, v169
    v_add_f32 v74, v74, v170
    v_add_f32 v75, v75, v171
    v_add_f32 v76, v76, v172
    v_add_f32 v77, v77, v173
    v_add_f32 v78, v78, v174
    v_add_f32 v79, v79, v175
    v_add_f32 v64, v64, v176
    v_add_f32 v65, v65, v177
    v_add_f32 v66, v66, v178
    v_add_f32 v67, v67, v179
    v_add_f32 v68, v68, v180
    v_add_f32 v69, v69, v181
    v_add_f32 v70, v70, v182
    v_add_f32 v71, v71, v183
    v_add_f32 v72, v72, v184
    v_add_f32 v73, v73, v185
    v_add_f32 v74, v74, v186
    v_add_f32 v75, v75, v187
    v_add_f32 v76, v76, v188
    v_add_f32 v77, v77, v189
    v_add_f32 v78, v78, v190
    v_add_f32 v79, v79, v191
    v_cvt_pk_bf16_f32 v96, v64, v72
    v_lshlrev_b32 v64, 16, v96
    v_and_b32 v72, 0xffff0000, v96
    v_mul_f32 v98, 0xbfb8aa3b, v64
    v_exp_f32 v98, v98
    s_nop 0
    v_add_f32 v98, 1.0, v98
    v_rcp_f32 v99, v98
    s_nop 0
    v_mul_f32 v97, v64, v99
    v_cvt_pk_bf16_f32 v96, v97, v97
    v_lshlrev_b32 v97, 16, v96
    v_mul_f32 v97, v97, v72
    v_cvt_pk_bf16_f32 v96, v97, v97
    v_and_b32 v80, 0xffff, v96
    v_lshlrev_b32 v81, 16, v96
    v_cvt_pk_bf16_f32 v96, v65, v73
    v_lshlrev_b32 v65, 16, v96
    v_and_b32 v73, 0xffff0000, v96
    v_mul_f32 v98, 0xbfb8aa3b, v65
    v_exp_f32 v98, v98
    s_nop 0
    v_add_f32 v98, 1.0, v98
    v_rcp_f32 v99, v98
    s_nop 0
    v_mul_f32 v97, v65, v99
    v_cvt_pk_bf16_f32 v96, v97, v97
    v_lshlrev_b32 v97, 16, v96
    v_mul_f32 v97, v97, v73
    v_cvt_pk_bf16_f32 v96, v97, v97
    v_and_b32 v82, 0xffff, v96
    v_lshlrev_b32 v83, 16, v96
    v_cvt_pk_bf16_f32 v96, v66, v74
    v_lshlrev_b32 v66, 16, v96
    v_and_b32 v74, 0xffff0000, v96
    v_mul_f32 v98, 0xbfb8aa3b, v66
    v_exp_f32 v98, v98
    s_nop 0
    v_add_f32 v98, 1.0, v98
    v_rcp_f32 v99, v98
    s_nop 0
    v_mul_f32 v97, v66, v99
    v_cvt_pk_bf16_f32 v96, v97, v97
    v_lshlrev_b32 v97, 16, v96
    v_mul_f32 v97, v97, v74
    v_cvt_pk_bf16_f32 v96, v97, v97
    v_and_b32 v84, 0xffff, v96
    v_lshlrev_b32 v85, 16, v96
    v_cvt_pk_bf16_f32 v96, v67, v75
    v_lshlrev_b32 v67, 16, v96
    v_and_b32 v75, 0xffff0000, v96
    v_mul_f32 v98, 0xbfb8aa3b, v67
    v_exp_f32 v98, v98
    s_nop 0
    v_add_f32 v98, 1.0, v98
    v_rcp_f32 v99, v98
    s_nop 0
    v_mul_f32 v97, v67, v99
    v_cvt_pk_bf16_f32 v96, v97, v97
    v_lshlrev_b32 v97, 16, v96
    v_mul_f32 v97, v97, v75
    v_cvt_pk_bf16_f32 v96, v97, v97
    v_and_b32 v86, 0xffff, v96
    v_lshlrev_b32 v87, 16, v96
    v_cvt_pk_bf16_f32 v96, v68, v76
    v_lshlrev_b32 v68, 16, v96
    v_and_b32 v76, 0xffff0000, v96
    v_mul_f32 v98, 0xbfb8aa3b, v68
    v_exp_f32 v98, v98
    s_nop 0
    v_add_f32 v98, 1.0, v98
    v_rcp_f32 v99, v98
    s_nop 0
    v_mul_f32 v97, v68, v99
    v_cvt_pk_bf16_f32 v96, v97, v97
    v_lshlrev_b32 v97, 16, v96
    v_mul_f32 v97, v97, v76
    v_cvt_pk_bf16_f32 v96, v97, v97
    v_and_b32 v88, 0xffff, v96
    v_lshlrev_b32 v89, 16, v96
    v_cvt_pk_bf16_f32 v96, v69, v77
    v_lshlrev_b32 v69, 16, v96
    v_and_b32 v77, 0xffff0000, v96
    v_mul_f32 v98, 0xbfb8aa3b, v69
    v_exp_f32 v98, v98
    s_nop 0
    v_add_f32 v98, 1.0, v98
    v_rcp_f32 v99, v98
    s_nop 0
    v_mul_f32 v97, v69, v99
    v_cvt_pk_bf16_f32 v96, v97, v97
    v_lshlrev_b32 v97, 16, v96
    v_mul_f32 v97, v97, v77
    v_cvt_pk_bf16_f32 v96, v97, v97
    v_and_b32 v90, 0xffff, v96
    v_lshlrev_b32 v91, 16, v96
    v_cvt_pk_bf16_f32 v96, v70, v78
    v_lshlrev_b32 v70, 16, v96
    v_and_b32 v78, 0xffff0000, v96
    v_mul_f32 v98, 0xbfb8aa3b, v70
    v_exp_f32 v98, v98
    s_nop 0
    v_add_f32 v98, 1.0, v98
    v_rcp_f32 v99, v98
    s_nop 0
    v_mul_f32 v97, v70, v99
    v_cvt_pk_bf16_f32 v96, v97, v97
    v_lshlrev_b32 v97, 16, v96
    v_mul_f32 v97, v97, v78
    v_cvt_pk_bf16_f32 v96, v97, v97
    v_and_b32 v92, 0xffff, v96
    v_lshlrev_b32 v93, 16, v96
    v_cvt_pk_bf16_f32 v96, v71, v79
    v_lshlrev_b32 v71, 16, v96
    v_and_b32 v79, 0xffff0000, v96
    v_mul_f32 v98, 0xbfb8aa3b, v71
    v_exp_f32 v98, v98
    s_nop 0
    v_add_f32 v98, 1.0, v98
    v_rcp_f32 v99, v98
    s_nop 0
    v_mul_f32 v97, v71, v99
    v_cvt_pk_bf16_f32 v96, v97, v97
    v_lshlrev_b32 v97, 16, v96
    v_mul_f32 v97, v97, v79
    v_cvt_pk_bf16_f32 v96, v97, v97
    v_and_b32 v94, 0xffff, v96
    v_lshlrev_b32 v95, 16, v96
    v_mov_b32 v96, 0
    v_mov_b32 v97, 0
    v_mov_b32 v98, 0
    v_mov_b32 v99, 0
    v_mov_b32 v100, 0
    v_mov_b32 v101, 0
    v_mov_b32 v102, 0
    v_mov_b32 v103, 0
    v_mov_b32 v104, 0
    v_mov_b32 v105, 0
    v_mov_b32 v106, 0
    v_mov_b32 v107, 0
    v_mov_b32 v108, 0
    v_mov_b32 v109, 0
    v_mov_b32 v110, 0
    v_mov_b32 v111, 0
    v_dot2_f32_bf16 v96, v48, v80, v96
    v_dot2_f32_bf16 v97, v48, v81, v97
    v_dot2_f32_bf16 v104, v48, v88, v104
    v_dot2_f32_bf16 v105, v48, v89, v105
    v_dot2_f32_bf16 v98, v49, v80, v98
    v_dot2_f32_bf16 v99, v49, v81, v99
    v_dot2_f32_bf16 v106, v49, v88, v106
    v_dot2_f32_bf16 v107, v49, v89, v107
    v_dot2_f32_bf16 v100, v50, v80, v100
    v_dot2_f32_bf16 v101, v50, v81, v101
    v_dot2_f32_bf16 v108, v50, v88, v108
    v_dot2_f32_bf16 v109, v50, v89, v109
    v_dot2_f32_bf16 v102, v51, v80, v102
    v_dot2_f32_bf16 v103, v51, v81, v103
    v_dot2_f32_bf16 v110, v51, v88, v110
    v_dot2_f32_bf16 v111, v51, v89, v111
    v_dot2_f32_bf16 v96, v52, v82, v96
    v_dot2_f32_bf16 v97, v52, v83, v97
    v_dot2_f32_bf16 v104, v52, v90, v104
    v_dot2_f32_bf16 v105, v52, v91, v105
    v_dot2_f32_bf16 v98, v53, v82, v98
    v_dot2_f32_bf16 v99, v53, v83, v99
    v_dot2_f32_bf16 v106, v53, v90, v106
    v_dot2_f32_bf16 v107, v53, v91, v107
    v_dot2_f32_bf16 v100, v54, v82, v100
    v_dot2_f32_bf16 v101, v54, v83, v101
    v_dot2_f32_bf16 v108, v54, v90, v108
    v_dot2_f32_bf16 v109, v54, v91, v109
    v_dot2_f32_bf16 v102, v55, v82, v102
    v_dot2_f32_bf16 v103, v55, v83, v103
    v_dot2_f32_bf16 v110, v55, v90, v110
    v_dot2_f32_bf16 v111, v55, v91, v111
    v_dot2_f32_bf16 v96, v56, v84, v96
    v_dot2_f32_bf16 v97, v56, v85, v97
    v_dot2_f32_bf16 v104, v56, v92, v104
    v_dot2_f32_bf16 v105, v56, v93, v105
    v_dot2_f32_bf16 v98, v57, v84, v98
    v_dot2_f32_bf16 v99, v57, v85, v99
    v_dot2_f32_bf16 v106, v57, v92, v106
    v_dot2_f32_bf16 v107, v57, v93, v107
    v_dot2_f32_bf16 v100, v58, v84, v100
    v_dot2_f32_bf16 v101, v58, v85, v101
    v_dot2_f32_bf16 v108, v58, v92, v108
    v_dot2_f32_bf16 v109, v58, v93, v109
    v_dot2_f32_bf16 v102, v59, v84, v102
    v_dot2_f32_bf16 v103, v59, v85, v103
    v_dot2_f32_bf16 v110, v59, v92, v110
    v_dot2_f32_bf16 v111, v59, v93, v111
    v_dot2_f32_bf16 v96, v60, v86, v96
    v_dot2_f32_bf16 v97, v60, v87, v97
    v_dot2_f32_bf16 v104, v60, v94, v104
    v_dot2_f32_bf16 v105, v60, v95, v105
    v_dot2_f32_bf16 v98, v61, v86, v98
    v_dot2_f32_bf16 v99, v61, v87, v99
    v_dot2_f32_bf16 v106, v61, v94, v106
    v_dot2_f32_bf16 v107, v61, v95, v107
    v_dot2_f32_bf16 v100, v62, v86, v100
    v_dot2_f32_bf16 v101, v62, v87, v101
    v_dot2_f32_bf16 v108, v62, v94, v108
    v_dot2_f32_bf16 v109, v62, v95, v109
    v_dot2_f32_bf16 v102, v63, v86, v102
    v_dot2_f32_bf16 v103, v63, v87, v103
    v_dot2_f32_bf16 v110, v63, v94, v110
    v_dot2_f32_bf16 v111, v63, v95, v111
    s_nop 3
    s_nop 1
    v_permlane32_swap_b32 v96, v104
    v_permlane32_swap_b32 v97, v105
    v_permlane32_swap_b32 v98, v106
    v_permlane32_swap_b32 v99, v107
    v_permlane32_swap_b32 v100, v108
    v_permlane32_swap_b32 v101, v109
    v_permlane32_swap_b32 v102, v110
    v_permlane32_swap_b32 v103, v111
    s_nop 0
    v_add_f32 v96, v96, v104
    v_add_f32 v97, v97, v105
    v_add_f32 v98, v98, v106
    v_add_f32 v99, v99, v107
    v_add_f32 v100, v100, v108
    v_add_f32 v101, v101, v109
    v_add_f32 v102, v102, v110
    v_add_f32 v103, v103, v111
    s_nop 1
    v_permlane16_swap_b32 v96, v100
    v_permlane16_swap_b32 v97, v101
    v_permlane16_swap_b32 v98, v102
    v_permlane16_swap_b32 v99, v103
    s_nop 0
    v_add_f32 v96, v96, v100
    v_add_f32 v97, v97, v101
    v_add_f32 v98, v98, v102
    v_add_f32 v99, v99, v103
    s_nop 1
    v_add_f32_dpp v96, v96, v96 row_ror:8 row_mask:0xf bank_mask:0xf
    v_add_f32_dpp v97, v97, v97 row_ror:8 row_mask:0xf bank_mask:0xf
    v_add_f32_dpp v98, v98, v98 row_ror:8 row_mask:0xf bank_mask:0xf
    v_add_f32_dpp v99, v99, v99 row_ror:8 row_mask:0xf bank_mask:0xf
    v_lshrrev_b32 v11, 1, v3
    v_lshlrev_b32 v11, 8, v11
    v_and_b32 v12, 1, v3
    v_lshl_add_u32 v11, v12, 4, v11
    v_lshl_add_u32 v11, v9, 5, v11
    s_lshl_b32 s66, s74, 9
    s_add_u32 s66, s66, s34
    v_and_b32 v12, 8, v1
    v_cmp_eq_u32 vcc, 0, v12
    s_and_saveexec_b64 s[64:65], vcc
    buffer_store_dwordx4 v[96:99], v11, s[36:39], s66 offen offset:3072 sc1
    s_mov_b64 exec, s[64:65]
    s_branch HI_TAIL
H6_fred:
    s_cmp_lg_u32 s64, 28
    s_cbranch_scc1 HI_TAIL
    s_cmp_lg_u32 s28, 6
    s_cbranch_scc1 HI_TAIL
    s_mov_b32 s82, 0
LW_52:
    ds_read_b32 v25, v24 offset:40
    s_waitcnt lgkmcnt(0)
    v_readfirstlane_b32 s33, v25
    s_add_u32 s82, s82, 1
    s_cmp_ge_u32 s33, 1
    s_cbranch_scc1 LG_53
    s_sleep 8
    s_cmp_lt_u32 s82, 0x800000
    s_cbranch_scc1 LW_52
LG_53:
    s_mov_b32 s82, 0
LW_54:
    ds_read_b32 v25, v24 offset:0
    s_waitcnt lgkmcnt(0)
    v_readfirstlane_b32 s33, v25
    s_add_u32 s82, s82, 1
    s_cmp_ge_u32 s33, 80
    s_cbranch_scc1 LG_55
    s_sleep 8
    s_cmp_lt_u32 s82, 0x800000
    s_cbranch_scc1 LW_54
LG_55:
    v_lshlrev_b32 v13, 3, v1
    s_lshl_b32 s33, s35, 18
    v_add_u32 v201, 8192, v13
    v_add_u32 v202, 16384, v13
    v_add_u32 v203, 24576, v13
    v_add_u32 v204, 32768, v13
    v_add_u32 v205, 40960, v13
    v_add_u32 v206, 49152, v13
    v_add_u32 v207, 57344, v13
    v_add_u32 v208, 65536, v13
    v_add_u32 v209, 73728, v13
    v_add_u32 v210, 81920, v13
    v_add_u32 v211, 90112, v13
    v_add_u32 v212, 98304, v13
    v_add_u32 v213, 106496, v13
    v_add_u32 v214, 114688, v13
    v_add_u32 v215, 122880, v13
    v_add_u32 v216, 131072, v13
    v_add_u32 v217, 139264, v13
    v_add_u32 v218, 147456, v13
    v_add_u32 v219, 155648, v13
    v_add_u32 v220, 163840, v13
    v_add_u32 v221, 172032, v13
    v_add_u32 v222, 180224, v13
    v_add_u32 v223, 188416, v13
    v_add_u32 v224, 196608, v13
    v_add_u32 v225, 204800, v13
    v_add_u32 v226, 212992, v13
    v_add_u32 v227, 221184, v13
    s_mov_b32 s66, 0
PL_56:
    buffer_load_dwordx2 v[64:65], v13, s[36:39], s33 offen offset:3072 sc1
    buffer_load_dwordx2 v[66:67], v13, s[36:39], s33 offen offset:3584 sc1
    buffer_load_dwordx2 v[68:69], v201, s[36:39], s33 offen offset:3072 sc1
    buffer_load_dwordx2 v[70:71], v201, s[36:39], s33 offen offset:3584 sc1
    buffer_load_dwordx2 v[72:73], v202, s[36:39], s33 offen offset:3072 sc1
    buffer_load_dwordx2 v[74:75], v202, s[36:39], s33 offen offset:3584 sc1
    buffer_load_dwordx2 v[76:77], v203, s[36:39], s33 offen offset:3072 sc1
    buffer_load_dwordx2 v[78:79], v203, s[36:39], s33 offen offset:3584 sc1
    buffer_load_dwordx2 v[80:81], v204, s[36:39], s33 offen offset:3072 sc1
    buffer_load_dwordx2 v[82:83], v204, s[36:39], s33 offen offset:3584 sc1
    buffer_load_dwordx2 v[84:85], v205, s[36:39], s33 offen offset:3072 sc1
    buffer_load_dwordx2 v[86:87], v205, s[36:39], s33 offen offset:3584 sc1
    buffer_load_dwordx2 v[88:89], v206, s[36:39], s33 offen offset:3072 sc1
    buffer_load_dwordx2 v[90:91], v206, s[36:39], s33 offen offset:3584 sc1
    buffer_load_dwordx2 v[92:93], v207, s[36:39], s33 offen offset:3072 sc1
    buffer_load_dwordx2 v[94:95], v207, s[36:39], s33 offen offset:3584 sc1
    buffer_load_dwordx2 v[96:97], v208, s[36:39], s33 offen offset:3072 sc1
    buffer_load_dwordx2 v[98:99], v208, s[36:39], s33 offen offset:3584 sc1
    buffer_load_dwordx2 v[100:101], v209, s[36:39], s33 offen offset:3072 sc1
    buffer_load_dwordx2 v[102:103], v209, s[36:39], s33 offen offset:3584 sc1
    buffer_load_dwordx2 v[104:105], v210, s[36:39], s33 offen offset:3072 sc1
    buffer_load_dwordx2 v[106:107], v210, s[36:39], s33 offen offset:3584 sc1
    buffer_load_dwordx2 v[108:109], v211, s[36:39], s33 offen offset:3072 sc1
    buffer_load_dwordx2 v[110:111], v211, s[36:39], s33 offen offset:3584 sc1
    buffer_load_dwordx2 v[112:113], v212, s[36:39], s33 offen offset:3072 sc1
    buffer_load_dwordx2 v[114:115], v212, s[36:39], s33 offen offset:3584 sc1
    buffer_load_dwordx2 v[116:117], v213, s[36:39], s33 offen offset:3072 sc1
    buffer_load_dwordx2 v[118:119], v213, s[36:39], s33 offen offset:3584 sc1
    buffer_load_dwordx2 v[120:121], v214, s[36:39], s33 offen offset:3072 sc1
    buffer_load_dwordx2 v[122:123], v214, s[36:39], s33 offen offset:3584 sc1
    buffer_load_dwordx2 v[124:125], v215, s[36:39], s33 offen offset:3072 sc1
    buffer_load_dwordx2 v[126:127], v215, s[36:39], s33 offen offset:3584 sc1
    buffer_load_dwordx2 v[128:129], v216, s[36:39], s33 offen offset:3072 sc1
    buffer_load_dwordx2 v[130:131], v216, s[36:39], s33 offen offset:3584 sc1
    buffer_load_dwordx2 v[132:133], v217, s[36:39], s33 offen offset:3072 sc1
    buffer_load_dwordx2 v[134:135], v217, s[36:39], s33 offen offset:3584 sc1
    buffer_load_dwordx2 v[136:137], v218, s[36:39], s33 offen offset:3072 sc1
    buffer_load_dwordx2 v[138:139], v218, s[36:39], s33 offen offset:3584 sc1
    buffer_load_dwordx2 v[140:141], v219, s[36:39], s33 offen offset:3072 sc1
    buffer_load_dwordx2 v[142:143], v219, s[36:39], s33 offen offset:3584 sc1
    buffer_load_dwordx2 v[144:145], v220, s[36:39], s33 offen offset:3072 sc1
    buffer_load_dwordx2 v[146:147], v220, s[36:39], s33 offen offset:3584 sc1
    buffer_load_dwordx2 v[148:149], v221, s[36:39], s33 offen offset:3072 sc1
    buffer_load_dwordx2 v[150:151], v221, s[36:39], s33 offen offset:3584 sc1
    buffer_load_dwordx2 v[152:153], v222, s[36:39], s33 offen offset:3072 sc1
    buffer_load_dwordx2 v[154:155], v222, s[36:39], s33 offen offset:3584 sc1
    buffer_load_dwordx2 v[156:157], v223, s[36:39], s33 offen offset:3072 sc1
    buffer_load_dwordx2 v[158:159], v223, s[36:39], s33 offen offset:3584 sc1
    buffer_load_dwordx2 v[160:161], v224, s[36:39], s33 offen offset:3072 sc1
    buffer_load_dwordx2 v[162:163], v224, s[36:39], s33 offen offset:3584 sc1
    buffer_load_dwordx2 v[164:165], v225, s[36:39], s33 offen offset:3072 sc1
    buffer_load_dwordx2 v[166:167], v225, s[36:39], s33 offen offset:3584 sc1
    buffer_load_dwordx2 v[168:169], v226, s[36:39], s33 offen offset:3072 sc1
    buffer_load_dwordx2 v[170:171], v226, s[36:39], s33 offen offset:3584 sc1
    buffer_load_dwordx2 v[172:173], v227, s[36:39], s33 offen offset:3072 sc1
    buffer_load_dwordx2 v[174:175], v227, s[36:39], s33 offen offset:3584 sc1
    s_waitcnt vmcnt(0)
    v_mov_b32 v28, v64
    v_max3_u32 v28, v28, v65, v66
    v_max3_u32 v28, v28, v67, v68
    v_max3_u32 v28, v28, v69, v70
    v_max3_u32 v28, v28, v71, v72
    v_max3_u32 v28, v28, v73, v74
    v_max3_u32 v28, v28, v75, v76
    v_max3_u32 v28, v28, v77, v78
    v_max3_u32 v28, v28, v79, v80
    v_max3_u32 v28, v28, v81, v82
    v_max3_u32 v28, v28, v83, v84
    v_max3_u32 v28, v28, v85, v86
    v_max3_u32 v28, v28, v87, v88
    v_max3_u32 v28, v28, v89, v90
    v_max3_u32 v28, v28, v91, v92
    v_max3_u32 v28, v28, v93, v94
    v_max3_u32 v28, v28, v95, v96
    v_max3_u32 v28, v28, v97, v98
    v_max3_u32 v28, v28, v99, v100
    v_max3_u32 v28, v28, v101, v102
    v_max3_u32 v28, v28, v103, v104
    v_max3_u32 v28, v28, v105, v106
    v_max3_u32 v28, v28, v107, v108
    v_max3_u32 v28, v28, v109, v110
    v_max3_u32 v28, v28, v111, v112
    v_max3_u32 v28, v28, v113, v114
    v_max3_u32 v28, v28, v115, v116
    v_max3_u32 v28, v28, v117, v118
    v_max3_u32 v28, v28, v119, v120
    v_max3_u32 v28, v28, v121, v122
    v_max3_u32 v28, v28, v123, v124
    v_max3_u32 v28, v28, v125, v126
    v_max3_u32 v28, v28, v127, v128
    v_max3_u32 v28, v28, v129, v130
    v_max3_u32 v28, v28, v131, v132
    v_max3_u32 v28, v28, v133, v134
    v_max3_u32 v28, v28, v135, v136
    v_max3_u32 v28, v28, v137, v138
    v_max3_u32 v28, v28, v139, v140
    v_max3_u32 v28, v28, v141, v142
    v_max3_u32 v28, v28, v143, v144
    v_max3_u32 v28, v28, v145, v146
    v_max3_u32 v28, v28, v147, v148
    v_max3_u32 v28, v28, v149, v150
    v_max3_u32 v28, v28, v151, v152
    v_max3_u32 v28, v28, v153, v154
    v_max3_u32 v28, v28, v155, v156
    v_max3_u32 v28, v28, v157, v158
    v_max3_u32 v28, v28, v159, v160
    v_max3_u32 v28, v28, v161, v162
    v_max3_u32 v28, v28, v163, v164
    v_max3_u32 v28, v28, v165, v166
    v_max3_u32 v28, v28, v167, v168
    v_max3_u32 v28, v28, v169, v170
    v_max3_u32 v28, v28, v171, v172
    v_max3_u32 v28, v28, v173, v174
    v_max_u32 v28, v28, v175
    v_cmp_eq_u32 vcc, -1, v28
    s_add_u32 s66, s66, 1
    s_cmp_eq_u64 vcc, 0
    s_cbranch_scc1 PG_57
    s_sleep 64
    s_cmp_lt_u32 s66, 400000
    s_cbranch_scc1 PL_56
PG_57:
    v_add_f32 v64, v64, v66
    v_add_f32 v65, v65, v67
    v_add_f32 v64, v64, v68
    v_add_f32 v65, v65, v69
    v_add_f32 v64, v64, v70
    v_add_f32 v65, v65, v71
    v_add_f32 v64, v64, v72
    v_add_f32 v65, v65, v73
    v_add_f32 v64, v64, v74
    v_add_f32 v65, v65, v75
    v_add_f32 v64, v64, v76
    v_add_f32 v65, v65, v77
    v_add_f32 v64, v64, v78
    v_add_f32 v65, v65, v79
    v_add_f32 v64, v64, v80
    v_add_f32 v65, v65, v81
    v_add_f32 v64, v64, v82
    v_add_f32 v65, v65, v83
    v_add_f32 v64, v64, v84
    v_add_f32 v65, v65, v85
    v_add_f32 v64, v64, v86
    v_add_f32 v65, v65, v87
    v_add_f32 v64, v64, v88
    v_add_f32 v65, v65, v89
    v_add_f32 v64, v64, v90
    v_add_f32 v65, v65, v91
    v_add_f32 v64, v64, v92
    v_add_f32 v65, v65, v93
    v_add_f32 v64, v64, v94
    v_add_f32 v65, v65, v95
    v_add_f32 v64, v64, v96
    v_add_f32 v65, v65, v97
    v_add_f32 v64, v64, v98
    v_add_f32 v65, v65, v99
    v_add_f32 v64, v64, v100
    v_add_f32 v65, v65, v101
    v_add_f32 v64, v64, v102
    v_add_f32 v65, v65, v103
    v_add_f32 v64, v64, v104
    v_add_f32 v65, v65, v105
    v_add_f32 v64, v64, v106
    v_add_f32 v65, v65, v107
    v_add_f32 v64, v64, v108
    v_add_f32 v65, v65, v109
    v_add_f32 v64, v64, v110
    v_add_f32 v65, v65, v111
    v_add_f32 v64, v64, v112
    v_add_f32 v65, v65, v113
    v_add_f32 v64, v64, v114
    v_add_f32 v65, v65, v115
    v_add_f32 v64, v64, v116
    v_add_f32 v65, v65, v117
    v_add_f32 v64, v64, v118
    v_add_f32 v65, v65, v119
    v_add_f32 v64, v64, v120
    v_add_f32 v65, v65, v121
    v_add_f32 v64, v64, v122
    v_add_f32 v65, v65, v123
    v_add_f32 v64, v64, v124
    v_add_f32 v65, v65, v125
    v_add_f32 v64, v64, v126
    v_add_f32 v65, v65, v127
    v_add_f32 v64, v64, v128
    v_add_f32 v65, v65, v129
    v_add_f32 v64, v64, v130
    v_add_f32 v65, v65, v131
    v_add_f32 v64, v64, v132
    v_add_f32 v65, v65, v133
    v_add_f32 v64, v64, v134
    v_add_f32 v65, v65, v135
    v_add_f32 v64, v64, v136
    v_add_f32 v65, v65, v137
    v_add_f32 v64, v64, v138
    v_add_f32 v65, v65, v139
    v_add_f32 v64, v64, v140
    v_add_f32 v65, v65, v141
    v_add_f32 v64, v64, v142
    v_add_f32 v65, v65, v143
    v_add_f32 v64, v64, v144
    v_add_f32 v65, v65, v145
    v_add_f32 v64, v64, v146
    v_add_f32 v65, v65, v147
    v_add_f32 v64, v64, v148
    v_add_f32 v65, v65, v149
    v_add_f32 v64, v64, v150
    v_add_f32 v65, v65, v151
    v_add_f32 v64, v64, v152
    v_add_f32 v65, v65, v153
    v_add_f32 v64, v64, v154
    v_add_f32 v65, v65, v155
    v_add_f32 v64, v64, v156
    v_add_f32 v65, v65, v157
    v_add_f32 v64, v64, v158
    v_add_f32 v65, v65, v159
    v_add_f32 v64, v64, v160
    v_add_f32 v65, v65, v161
    v_add_f32 v64, v64, v162
    v_add_f32 v65, v65, v163
    v_add_f32 v64, v64, v164
    v_add_f32 v65, v65, v165
    v_add_f32 v64, v64, v166
    v_add_f32 v65, v65, v167
    v_add_f32 v64, v64, v168
    v_add_f32 v65, v65, v169
    v_add_f32 v64, v64, v170
    v_add_f32 v65, v65, v171
    v_add_f32 v64, v64, v172
    v_add_f32 v65, v65, v173
    v_add_f32 v64, v64, v174
    v_add_f32 v65, v65, v175
    v_cvt_pk_bf16_f32 v66, v64, v65
    v_lshlrev_b32 v64, 16, v66
    v_and_b32 v65, 0xffff0000, v66
    v_mul_f32 v70, 0xbfb8aa3b, v64
    v_exp_f32 v70, v70
    s_nop 0
    v_add_f32 v70, 1.0, v70
    v_rcp_f32 v71, v70
    s_nop 0
    v_mul_f32 v68, v64, v71
    v_mul_f32 v70, 0xbfb8aa3b, v65
    v_exp_f32 v70, v70
    s_nop 0
    v_add_f32 v70, 1.0, v70
    v_rcp_f32 v71, v70
    s_nop 0
    v_mul_f32 v69, v65, v71
    v_cvt_pk_bf16_f32 v66, v68, v69
    v_lshlrev_b32 v68, 16, v66
    v_and_b32 v69, 0xffff0000, v66
    v_add_u32 v13, 147456, v13
    ds_write_b64 v13, v[68:69]
    s_waitcnt lgkmcnt(0)
    s_branch HI_TAIL
HI_TAIL:
    s_waitcnt vmcnt(0)
    v_lshlrev_b32 v8, 4, v5
    v_add_u32 v8, 144384, v8
    v_mov_b32 v96, 0
    v_mov_b32 v97, 0
    v_mov_b32 v98, 0
    v_mov_b32 v99, 0
    v_mov_b32 v100, 0
    v_mov_b32 v101, 0
    v_mov_b32 v102, 0
    v_mov_b32 v103, 0
    v_mov_b32 v104, 0
    v_mov_b32 v105, 0
    v_mov_b32 v106, 0
    v_mov_b32 v107, 0
    v_mov_b32 v108, 0
    v_mov_b32 v109, 0
    v_mov_b32 v110, 0
    v_mov_b32 v111, 0
    v_lshrrev_b32 v11, 1, v3
    v_lshlrev_b32 v11, 8, v11
    v_and_b32 v12, 1, v3
    v_lshl_add_u32 v11, v12, 4, v11
    v_lshl_add_u32 v11, v6, 5, v11
    s_sub_u32 s33, s28, 4
    s_lshl_b32 s33, s33, 9
    s_add_u32 s33, s33, 145408
    v_add_u32 v11, s33, v11
    s_barrier
    s_barrier
    ds_read_b128 v[16:19], v8
    ds_read_b128 v[20:23], v8 offset:512
    s_waitcnt lgkmcnt(0)
    v_lshlrev_b32 v24, 16, v16
    v_lshlrev_b32 v25, 16, v17
    v_lshlrev_b32 v26, 16, v18
    v_lshlrev_b32 v27, 16, v19
    v_lshlrev_b32 v28, 16, v20
    v_lshlrev_b32 v29, 16, v21
    v_lshlrev_b32 v30, 16, v22
    v_lshlrev_b32 v31, 16, v23
    v_dot2_f32_bf16 v96, v32, v16, v96
    v_dot2_f32_bf16 v97, v32, v24, v97
    v_dot2_f32_bf16 v104, v32, v20, v104
    v_dot2_f32_bf16 v105, v32, v28, v105
    v_dot2_f32_bf16 v98, v33, v16, v98
    v_dot2_f32_bf16 v99, v33, v24, v99
    v_dot2_f32_bf16 v106, v33, v20, v106
    v_dot2_f32_bf16 v107, v33, v28, v107
    v_dot2_f32_bf16 v100, v34, v16, v100
    v_dot2_f32_bf16 v101, v34, v24, v101
    v_dot2_f32_bf16 v108, v34, v20, v108
    v_dot2_f32_bf16 v109, v34, v28, v109
    v_dot2_f32_bf16 v102, v35, v16, v102
    v_dot2_f32_bf16 v103, v35, v24, v103
    v_dot2_f32_bf16 v110, v35, v20, v110
    v_dot2_f32_bf16 v111, v35, v28, v111
    v_dot2_f32_bf16 v96, v36, v17, v96
    v_dot2_f32_bf16 v97, v36, v25, v97
    v_dot2_f32_bf16 v104, v36, v21, v104
    v_dot2_f32_bf16 v105, v36, v29, v105
    v_dot2_f32_bf16 v98, v37, v17, v98
    v_dot2_f32_bf16 v99, v37, v25, v99
    v_dot2_f32_bf16 v106, v37, v21, v106
    v_dot2_f32_bf16 v107, v37, v29, v107
    v_dot2_f32_bf16 v100, v38, v17, v100
    v_dot2_f32_bf16 v101, v38, v25, v101
    v_dot2_f32_bf16 v108, v38, v21, v108
    v_dot2_f32_bf16 v109, v38, v29, v109
    v_dot2_f32_bf16 v102, v39, v17, v102
    v_dot2_f32_bf16 v103, v39, v25, v103
    v_dot2_f32_bf16 v110, v39, v21, v110
    v_dot2_f32_bf16 v111, v39, v29, v111
    v_dot2_f32_bf16 v96, v40, v18, v96
    v_dot2_f32_bf16 v97, v40, v26, v97
    v_dot2_f32_bf16 v104, v40, v22, v104
    v_dot2_f32_bf16 v105, v40, v30, v105
    v_dot2_f32_bf16 v98, v41, v18, v98
    v_dot2_f32_bf16 v99, v41, v26, v99
    v_dot2_f32_bf16 v106, v41, v22, v106
    v_dot2_f32_bf16 v107, v41, v30, v107
    v_dot2_f32_bf16 v100, v42, v18, v100
    v_dot2_f32_bf16 v101, v42, v26, v101
    v_dot2_f32_bf16 v108, v42, v22, v108
    v_dot2_f32_bf16 v109, v42, v30, v109
    v_dot2_f32_bf16 v102, v43, v18, v102
    v_dot2_f32_bf16 v103, v43, v26, v103
    v_dot2_f32_bf16 v110, v43, v22, v110
    v_dot2_f32_bf16 v111, v43, v30, v111
    v_dot2_f32_bf16 v96, v44, v19, v96
    v_dot2_f32_bf16 v97, v44, v27, v97
    v_dot2_f32_bf16 v104, v44, v23, v104
    v_dot2_f32_bf16 v105, v44, v31, v105
    v_dot2_f32_bf16 v98, v45, v19, v98
    v_dot2_f32_bf16 v99, v45, v27, v99
    v_dot2_f32_bf16 v106, v45, v23, v106
    v_dot2_f32_bf16 v107, v45, v31, v107
    v_dot2_f32_bf16 v100, v46, v19, v100
    v_dot2_f32_bf16 v101, v46, v27, v101
    v_dot2_f32_bf16 v108, v46, v23, v108
    v_dot2_f32_bf16 v109, v46, v31, v109
    v_dot2_f32_bf16 v102, v47, v19, v102
    v_dot2_f32_bf16 v103, v47, v27, v103
    v_dot2_f32_bf16 v110, v47, v23, v110
    v_dot2_f32_bf16 v111, v47, v31, v111
    s_nop 3
    s_nop 1
    v_permlane32_swap_b32 v96, v104
    v_permlane32_swap_b32 v97, v105
    v_permlane32_swap_b32 v98, v106
    v_permlane32_swap_b32 v99, v107
    v_permlane32_swap_b32 v100, v108
    v_permlane32_swap_b32 v101, v109
    v_permlane32_swap_b32 v102, v110
    v_permlane32_swap_b32 v103, v111
    s_nop 0
    v_add_f32 v96, v96, v104
    v_add_f32 v97, v97, v105
    v_add_f32 v98, v98, v106
    v_add_f32 v99, v99, v107
    v_add_f32 v100, v100, v108
    v_add_f32 v101, v101, v109
    v_add_f32 v102, v102, v110
    v_add_f32 v103, v103, v111
    s_nop 1
    v_permlane16_swap_b32 v96, v100
    v_permlane16_swap_b32 v97, v101
    v_permlane16_swap_b32 v98, v102
    v_permlane16_swap_b32 v99, v103
    s_nop 0
    v_add_f32 v96, v96, v100
    v_add_f32 v97, v97, v101
    v_add_f32 v98, v98, v102
    v_add_f32 v99, v99, v103
    s_nop 1
    v_add_f32_dpp v96, v96, v96 row_ror:8 row_mask:0xf bank_mask:0xf
    v_add_f32_dpp v97, v97, v97 row_ror:8 row_mask:0xf bank_mask:0xf
    v_add_f32_dpp v98, v98, v98 row_ror:8 row_mask:0xf bank_mask:0xf
    v_add_f32_dpp v99, v99, v99 row_ror:8 row_mask:0xf bank_mask:0xf
    v_and_b32 v12, 8, v1
    v_cmp_eq_u32 vcc, 0, v12
    s_and_saveexec_b64 s[64:65], vcc
    ds_write_b128 v11, v[96:99]
    s_mov_b64 exec, s[64:65]
    s_waitcnt lgkmcnt(0)
    s_barrier
    s_cmp_ge_u32 s28, 6
    s_cbranch_scc1 DONE
    v_lshlrev_b32 v12, 2, v4
    v_add_u32 v13, 145408, v12
    ds_read_b32 v16, v13 offset:0
    ds_read_b32 v17, v13 offset:512
    ds_read_b32 v18, v13 offset:1024
    ds_read_b32 v19, v13 offset:1536
    s_waitcnt lgkmcnt(0)
    v_add_f32 v16, v16, v17
    v_add_f32 v18, v18, v19
    v_add_f32 v16, v16, v18
    buffer_store_dword v16, v12, s[36:39], s34 offen offset:2560 sc1
DONE:
    s_endpgm
.section .rodata,"a"
.p2align 6
.amdhsa_kernel recurrent_scan__gqa_block_cached__glu_gated_swiglu__decode_kernel
  .amdhsa_next_free_vgpr 248
  .amdhsa_next_free_sgpr 100
  .amdhsa_accum_offset 248
  .amdhsa_group_segment_fixed_size 0
  .amdhsa_kernarg_size 96
  .amdhsa_user_sgpr_count 2
  .amdhsa_user_sgpr_kernarg_segment_ptr 1
  .amdhsa_system_sgpr_workgroup_id_x 1
  .amdhsa_float_denorm_mode_32 3
.end_amdhsa_kernel
```
